```python
import torch

def _softmax(x, axis=-1):
    return torch.softmax(x, dim=axis)
def _gelu(x):
    return torch.nn.functional.gelu(x, approximate="tanh")
def _silu(x):
    return torch.nn.functional.silu(x)
def _sigmoid(x):
    return torch.sigmoid(x)
def _layernorm(x, axis=-1, eps=1e-5):
    m = x.mean(dim=axis, keepdim=True)
    v = x.var(dim=axis, keepdim=True, unbiased=False)
    return (x - m) / torch.sqrt(v + eps)
def _scatter_add(tgt, idx, src, axis=0):
    return tgt.clone().index_add_(axis, idx, src)
def _segment_sum(src, seg, n):
    out = torch.zeros((n,) + src.shape[1:], dtype=src.dtype)
    return out.index_add_(0, seg, src)
def _pad(x, pw):
    flat = tuple(v for pair in reversed(pw) for v in pair)
    return torch.nn.functional.pad(x, flat)

kernel_name = 'sequential_preLN__ssm_conv_h3__glu_gated_glu__prompt'

def setup_inputs():

    _w = (lambda a: (lambda t: t.to(torch.bfloat16) if t.is_floating_point() else t)(torch.as_tensor(a)))
    def _A_setup():
        B, S, D = 1, 2048, 512
        ks = 4
        return {
            "q": _w((lambda *s: torch.randn(*s, dtype=torch.bfloat16) * 0.05)(B, S, D)),
            "k": _w((lambda *s: torch.randn(*s, dtype=torch.bfloat16) * 0.4)(B, S, D)),
            "v": _w((lambda *s: torch.randn(*s, dtype=torch.bfloat16) * 0.4)(B, S, D)),
            "shift_k": _w((lambda *s: torch.randn(*s, dtype=torch.bfloat16) * 0.4)(D, ks) * 0.5),
            "ssm_k": _w((lambda *s: torch.randn(*s, dtype=torch.bfloat16) * 0.4)(D, S) * (1.0 / S ** 0.5)),
            "ssm_D": _w((lambda *s: torch.randn(*s, dtype=torch.bfloat16) * 0.4)(D)),
        }
    _A_in = _A_setup()

    def _B_setup():
        B, S, D, F = 1, 2048, 512, 1376
        return {
            "x": _w((lambda *s: torch.randn(*s, dtype=torch.bfloat16) * 0.05)(B, S, D)),
            "w_gate": _w((lambda *s: torch.randn(*s, dtype=torch.bfloat16) * 0.05)(D, F)),
            "w_up": _w((lambda *s: torch.randn(*s, dtype=torch.bfloat16) * 0.05)(D, F)),
            "w_down": _w((lambda *s: torch.randn(*s, dtype=torch.bfloat16) * 0.05)(F, D)),
        }
    _B_in = _B_setup()

    return {
        "A_q": _A_in["q"],
        "A_k": _A_in["k"],
        "A_v": _A_in["v"],
        "A_shift_k": _A_in["shift_k"],
        "A_ssm_k": _A_in["ssm_k"],
        "A_ssm_D": _A_in["ssm_D"],
        "B_x": _B_in["x"],
        "B_w_gate": _B_in["w_gate"],
        "B_w_up": _B_in["w_up"],
        "B_w_down": _B_in["w_down"],
    }

def reference(A_q, A_k, A_v, A_shift_k, A_ssm_k, A_ssm_D, B_x, B_w_gate, B_w_up, B_w_down):
    def _A_ref(q, k, v, shift_k, ssm_k, ssm_D):
        B, S, D = q.shape
        ks = shift_k.shape[-1]
        k_pad = _pad(k, ((0, 0), (ks - 1, 0), (0, 0)))
        k_shift = torch.zeros_like(k)
        for t in range(ks):
            k_shift = k_shift + k_pad[:, t:t + S, :] * shift_k[:, ks - 1 - t][None, None, :]
        kv = k_shift * v
        L = 2 * S
        kv_pad = _pad(kv, ((0, 0), (0, S), (0, 0)))
        kf_pad = _pad(ssm_k, ((0, 0), (0, S)))
        kv_f = (lambda x, axes=(-2,-1): torch.fft.rfft2(x.float(), dim=axes))(kv_pad[:, None, :, :], axes=(1, 2))
        kf_f = (lambda x, axes=(-2,-1): torch.fft.rfft2(x.float(), dim=axes))(kf_pad[:, None, :], axes=(1, 2))
        kf_f = (lambda x, *d: x.permute(*d))(kf_f, 1, 2, 0)
        y_f = kv_f * kf_f[None, :, :, :]
        y = (lambda x, s, axes=(-2,-1): torch.fft.irfft2(x, s=s, dim=axes).to(torch.bfloat16))(y_f, (1, L), axes=(1, 2))[:, 0, :S, :]
        y = y + kv * ssm_D[None, None, :]
        return q * y

    def _B_ref(x, w_gate, w_up, w_down):
        g = torch.einsum("bsd,df->bsf", x, w_gate)
        u = torch.einsum("bsd,df->bsf", x, w_up)
        h = _sigmoid(g) * u
        return torch.einsum("bsf,fd->bsd", h, w_down)

    x = A_q
    h = x + _A_ref(_layernorm(x, axis=-1), A_k, A_v, A_shift_k, A_ssm_k, A_ssm_D)
    h2 = h + _B_ref(_layernorm(h, axis=-1), B_w_gate, B_w_up, B_w_down)
    return h2
```

```asm
; @launch grid=(256,1,1) block=(256,1,1) lds=163840
.amdgcn_target "amdgcn-amd-amdhsa--gfx950"
.text
.globl sequential_preLN__ssm_conv_h3__glu_gated_glu__prompt_kernel
.p2align 8
.type sequential_preLN__ssm_conv_h3__glu_gated_glu__prompt_kernel,@function
sequential_preLN__ssm_conv_h3__glu_gated_glu__prompt_kernel:
  s_load_dwordx16 s[64:79], s[0:1], 0
  s_getpc_b64 s[6:7]
  s_bfe_u32 s3, s2, 0x20003
  s_lshl_b32 s3, s3, 12
  v_lshl_add_u32 v1, v0, 4, s3
  global_load_dword v255, v1, s[6:7]
  s_load_dwordx8 s[84:91], s[0:1], 64
  s_load_dwordx2 s[92:93], s[0:1], 96
  s_cmpk_ge_u32 s2, 256
  s_cbranch_scc1 L_end
  v_readfirstlane_b32 s56, v0
  s_and_b32 s54, s2, 7
  s_lshr_b32 s55, s2, 3
  s_lshr_b32 s56, s56, 6
  v_and_b32 v2, 63, v0
  v_and_b32 v3, 7, v0
  v_xor_b32 v3, s56, v3
  v_lshlrev_b32 v3, 4, v3
  v_lshrrev_b32 v4, 3, v2
  v_lshl_add_u32 v3, v4, 10, v3
  s_lshl_b32 s60, s55, 16
  s_lshl_b32 s61, s54, 7
  s_add_u32 s60, s60, s61
  s_lshl_b32 s61, s56, 13
  s_add_u32 s60, s60, s61
  v_add_u32 v3, s60, v3
  v_xor_b32 v4, 64, v3
  v_add_u32 v4, 32768, v4
  v_subrev_u32 v5, 3072, v3
  v_subrev_u32 v6, 3072, v4
  s_lshl_b32 s24, s56, 10
  s_add_u32 m0, s24, 118784
  s_mov_b32 s14, 2097152
  s_mov_b32 s15, 0x20000
  s_mov_b32 s18, 2097152
  s_mov_b32 s19, 0x20000
  s_memrealtime s[20:21]
  v_mov_b32 v62, 0
  s_or_b32 s62, s2, s56
  s_waitcnt lgkmcnt(0)
  s_cbranch_scc1 L_tokb
  s_mov_b64 exec, 1
  s_and_b32 s20, s20, 0xfffffff8
  s_or_b32 s20, s20, 8
  s_xor_b32 s21, s21, 0x5bd1e995
  v_mov_b32 v60, s20
  v_mov_b32 v61, s21
  global_store_dwordx2 v62, v[60:61], s[90:91] sc1
  s_mov_b64 exec, -1
L_tokb:
  s_mov_b64 s[12:13], s[66:67]
  s_mov_b64 s[16:17], s[68:69]
  buffer_load_dwordx4 v5, s[12:15], 0 offen  lds
  s_add_u32 m0, s24, 122880
  v_add_u32 v5, 65536, v5
  buffer_load_dwordx4 v6, s[12:15], 0 offen  lds
  s_add_u32 m0, s24, 128000
  s_nop 0
  buffer_load_dwordx4 v3, s[16:19], 0 offen nt lds
  s_add_u32 m0, s24, 132096
  v_lshrrev_b32 v7, 3, v0
  buffer_load_dwordx4 v4, s[16:19], 0 offen nt lds
  s_mov_b32 m0, 126976
  s_cmp_lg_u32 s56, 0
  s_cbranch_scc1 L_nok8
  buffer_load_dwordx4 v5, s[12:15], 0 offen  lds
L_nok8:
  s_lshl_b32 s61, s54, 9
  v_lshl_add_u32 v5, v7, 4, s61
  global_load_dwordx4 v[8:11], v5, s[70:71]
  s_mov_b64 s[16:17], s[64:65]
  s_add_u32 m0, s24, 136192
  s_nop 0
  buffer_load_dwordx4 v3, s[16:19], 0 offen  lds
  s_add_u32 m0, s24, 140288
  s_mov_b64 s[26:27], s[64:65]
  buffer_load_dwordx4 v4, s[16:19], 0 offen  lds
  s_lshl_b32 s62, s54, 18
  s_lshl_b32 s63, s55, 13
  s_add_u32 s62, s62, s63
  v_lshl_add_u32 v5, v0, 4, s62
  v_subrev_u32 v6, 8, v5
  v_max_i32 v6, 0, v6
  global_load_dwordx4 v[14:17], v5, s[72:73] nt
  global_load_dwordx2 v[12:13], v6, s[72:73]
  v_add_u32 v5, 4096, v5
  global_load_dwordx4 v[20:23], v5, s[72:73] nt
  global_load_dwordx2 v[18:19], v5, s[72:73] offset:-8
  s_lshl_b32 s62, s54, 7
  s_lshl_b32 s63, s55, 2
  s_add_u32 s62, s62, s63
  s_load_dword s11, s[74:75], s62
  s_mov_b64 s[28:29], s[78:79]
  s_mov_b64 s[32:33], s[84:85]
  s_mov_b64 s[36:37], s[86:87]
  s_mov_b64 s[40:41], s[88:89]
  s_mov_b64 s[48:49], s[90:91]
  s_mov_b64 s[44:45], s[92:93]
  s_mov_b32 s46, 16777216
  s_mov_b32 s47, 0x20000
  s_mov_b32 s30, 1409024
  s_mov_b32 s31, 0x20000
  s_mov_b32 s34, 1409024
  s_mov_b32 s35, 0x20000
  s_mov_b32 s38, 1409024
  s_mov_b32 s39, 0x20000
  s_mov_b32 s42, 2097152
  s_mov_b32 s43, 0x20000
  s_mov_b32 s50, 256
  s_mov_b32 s51, 0x20000
  s_mov_b32 s57, s2
  s_and_b32 s59, s55, 15
  s_lshr_b32 s58, s55, 4
  s_lshl_b32 s80, s54, 1
  s_add_u32 s58, s58, s80
  s_mov_b32 s80, 0x05040100
  s_mov_b32 s81, 0x07060302
  s_mov_b32 s82, 0xffff0000
  s_bitcmp1_b32 s56, 0
  s_cselect_b64 s[12:13], s[32:33], s[28:29]
  s_mov_b32 s14, 1409024
  s_mov_b32 s15, 0x20000
  s_mul_i32 s22, s54, 786432
  s_add_u32 s22, s22, 4194304
  s_lshl_b32 s61, s55, 7
  s_add_u32 s23, s22, s61
  s_mov_b64 exec, 0xff
  s_lshl_b32 s69, s54, 10
  s_add_u32 s69, s69, 65536
  v_lshlrev_b32 v5, 7, v2
  buffer_load_dword a255, v5, s[44:47], s69 offen sc1
  s_mov_b64 exec, -1
  v_and_b32 v5, 7, v0
  v_lshlrev_b32 v6, 14, v7
  v_lshl_add_u32 v6, v5, 4, v6
  v_lshrrev_b32 v63, 2, v7
  v_xor_b32 v64, v63, v5
  v_add_u32 v65, 1, v5
  v_and_b32 v65, 7, v65
  v_xor_b32 v65, v63, v65
  v_and_b32 v63, 3, v7
  v_lshlrev_b32 v63, 2, v63
  v_lshl_add_u32 v63, v5, 10, v63
  v_lshl_add_u32 v64, v64, 4, v63
  v_lshl_add_u32 v65, v65, 4, v63
  v_add_u32 v64, 118784, v64
  v_add_u32 v65, 118784, v65
  s_add_u32 s70, s23, 4096
  s_add_u32 s71, s23, 8192
  s_add_u32 s72, s23, 12288
  v_mov_b32 v84, 0
  v_mov_b32 v85, 0
  v_mov_b32 v86, 0
  v_mov_b32 v87, 0
  v_lshrrev_b32 v88, 1, v0
  v_mul_u32_u24 v88, 4160, v88
  v_and_b32 v89, 1, v0
  v_lshl_add_u32 v88, v89, 4, v88
  v_add_u32 v88, 21504, v88
  v_subrev_u32 v89, 16, v0
  v_lshrrev_b32 v90, 5, v89
  v_mul_u32_u24 v90, 4608, v90
  v_and_b32 v89, 31, v89
  v_lshl_add_u32 v89, v89, 4, v90
  v_cmp_gt_u32 vcc, 16, v0
  v_sub_u32 v66, 255, v0
  v_lshlrev_b32 v66, 4, v66
  v_cndmask_b32 v88, v89, v88, vcc
  v_cmp_gt_u32 vcc, 80, v0
  s_and_saveexec_b64 s[62:63], vcc
  s_cbranch_execz L_nozero
  ds_write_b128 v88, v[84:87] offset:0
L_nozero:
  s_mov_b64 exec, -1
  s_waitcnt vmcnt(8) lgkmcnt(0)
  s_barrier
  s_and_b32 s79, s11, s82
  s_lshl_b32 s78, s11, 16
  ds_read_b32 v32, v64 offset:0
  ds_read_b32 v33, v64 offset:128
  ds_read_b32 v34, v64 offset:256
  ds_read_b32 v35, v64 offset:384
  ds_read_b32 v36, v64 offset:512
  ds_read_b32 v37, v64 offset:640
  ds_read_b32 v38, v64 offset:768
  ds_read_b32 v39, v64 offset:896
  ds_read_b32 v40, v65 offset:1024
  ds_read_b32 v41, v65 offset:1152
  ds_read_b32 v42, v65 offset:1280
  ds_read_b32 v44, v64 offset:9216
  ds_read_b32 v45, v64 offset:9344
  ds_read_b32 v46, v64 offset:9472
  ds_read_b32 v47, v64 offset:9600
  ds_read_b32 v48, v64 offset:9728
  ds_read_b32 v49, v64 offset:9856
  ds_read_b32 v50, v64 offset:9984
  ds_read_b32 v51, v64 offset:10112
  global_load_dwordx2 v[60:61], v62, s[48:49] sc1
  s_waitcnt vmcnt(8)
  v_lshlrev_b32 v150, 16, v8
  v_lshlrev_b32 v151, 16, v10
  v_and_b32 v152, s82, v8
  v_and_b32 v153, s82, v10
  v_lshlrev_b32 v154, 16, v9
  v_lshlrev_b32 v155, 16, v11
  v_and_b32 v156, s82, v9
  v_and_b32 v157, s82, v11
  s_waitcnt lgkmcnt(8)
  v_lshlrev_b32 v128, 16, v32
  v_and_b32 v129, s82, v32
  v_lshlrev_b32 v130, 16, v33
  v_and_b32 v131, s82, v33
  v_lshlrev_b32 v132, 16, v34
  v_and_b32 v133, s82, v34
  v_lshlrev_b32 v134, 16, v35
  v_and_b32 v135, s82, v35
  v_lshlrev_b32 v136, 16, v36
  v_and_b32 v137, s82, v36
  v_lshlrev_b32 v138, 16, v37
  v_and_b32 v139, s82, v37
  v_lshlrev_b32 v140, 16, v38
  v_and_b32 v141, s82, v38
  v_lshlrev_b32 v142, 16, v39
  v_and_b32 v143, s82, v39
  v_lshlrev_b32 v144, 16, v40
  v_and_b32 v145, s82, v40
  v_lshlrev_b32 v146, 16, v41
  v_and_b32 v147, s82, v41
  v_lshlrev_b32 v148, 16, v42
  v_and_b32 v149, s82, v42
  v_pk_mul_f32 v[174:175], v[128:129], v[156:157]
  v_pk_mul_f32 v[176:177], v[130:131], v[156:157]
  v_pk_mul_f32 v[178:179], v[132:133], v[156:157]
  v_pk_mul_f32 v[180:181], v[134:135], v[156:157]
  v_pk_mul_f32 v[182:183], v[136:137], v[156:157]
  v_pk_mul_f32 v[184:185], v[138:139], v[156:157]
  v_pk_mul_f32 v[186:187], v[140:141], v[156:157]
  v_pk_mul_f32 v[188:189], v[142:143], v[156:157]
  v_pk_fma_f32 v[174:175], v[130:131], v[154:155], v[174:175]
  v_pk_fma_f32 v[176:177], v[132:133], v[154:155], v[176:177]
  v_pk_fma_f32 v[178:179], v[134:135], v[154:155], v[178:179]
  v_pk_fma_f32 v[180:181], v[136:137], v[154:155], v[180:181]
  v_pk_fma_f32 v[182:183], v[138:139], v[154:155], v[182:183]
  v_pk_fma_f32 v[184:185], v[140:141], v[154:155], v[184:185]
  v_pk_fma_f32 v[186:187], v[142:143], v[154:155], v[186:187]
  v_pk_fma_f32 v[188:189], v[144:145], v[154:155], v[188:189]
  v_pk_fma_f32 v[174:175], v[132:133], v[152:153], v[174:175]
  v_pk_fma_f32 v[176:177], v[134:135], v[152:153], v[176:177]
  v_pk_fma_f32 v[178:179], v[136:137], v[152:153], v[178:179]
  v_pk_fma_f32 v[180:181], v[138:139], v[152:153], v[180:181]
  v_pk_fma_f32 v[182:183], v[140:141], v[152:153], v[182:183]
  v_pk_fma_f32 v[184:185], v[142:143], v[152:153], v[184:185]
  v_pk_fma_f32 v[186:187], v[144:145], v[152:153], v[186:187]
  v_pk_fma_f32 v[188:189], v[146:147], v[152:153], v[188:189]
  v_pk_fma_f32 v[174:175], v[134:135], v[150:151], v[174:175]
  v_pk_fma_f32 v[176:177], v[136:137], v[150:151], v[176:177]
  v_pk_fma_f32 v[178:179], v[138:139], v[150:151], v[178:179]
  v_pk_fma_f32 v[180:181], v[140:141], v[150:151], v[180:181]
  v_pk_fma_f32 v[182:183], v[142:143], v[150:151], v[182:183]
  v_pk_fma_f32 v[184:185], v[144:145], v[150:151], v[184:185]
  v_pk_fma_f32 v[186:187], v[146:147], v[150:151], v[186:187]
  v_pk_fma_f32 v[188:189], v[148:149], v[150:151], v[188:189]
  s_waitcnt lgkmcnt(0)
  v_lshlrev_b32 v158, 16, v44
  v_and_b32 v159, s82, v44
  v_lshlrev_b32 v160, 16, v45
  v_and_b32 v161, s82, v45
  v_lshlrev_b32 v162, 16, v46
  v_and_b32 v163, s82, v46
  v_lshlrev_b32 v164, 16, v47
  v_and_b32 v165, s82, v47
  v_lshlrev_b32 v166, 16, v48
  v_and_b32 v167, s82, v48
  v_lshlrev_b32 v168, 16, v49
  v_and_b32 v169, s82, v49
  v_lshlrev_b32 v170, 16, v50
  v_and_b32 v171, s82, v50
  v_lshlrev_b32 v172, 16, v51
  v_and_b32 v173, s82, v51
  v_pk_mul_f32 v[174:175], v[174:175], v[158:159]
  v_pk_mul_f32 v[176:177], v[176:177], v[160:161]
  v_pk_mul_f32 v[178:179], v[178:179], v[162:163]
  v_pk_mul_f32 v[180:181], v[180:181], v[164:165]
  v_pk_mul_f32 v[182:183], v[182:183], v[166:167]
  v_pk_mul_f32 v[184:185], v[184:185], v[168:169]
  v_pk_mul_f32 v[186:187], v[186:187], v[170:171]
  v_pk_mul_f32 v[188:189], v[188:189], v[172:173]
  v_cvt_pk_bf16_f32 v190, v174, v176
  v_cvt_pk_bf16_f32 v191, v178, v180
  v_cvt_pk_bf16_f32 v192, v182, v184
  v_cvt_pk_bf16_f32 v193, v186, v188
  buffer_store_dwordx4 v[190:193], v6, s[44:47], s23 offen sc1
  v_cvt_pk_bf16_f32 v194, v175, v177
  v_cvt_pk_bf16_f32 v195, v179, v181
  v_cvt_pk_bf16_f32 v196, v183, v185
  v_cvt_pk_bf16_f32 v197, v187, v189
  buffer_store_dwordx4 v[194:197], v6, s[44:47], s70 offen sc1
  s_waitcnt vmcnt(8)
  s_barrier
  ds_read_b32 v52, v64 offset:17408
  ds_read_b32 v53, v64 offset:17536
  ds_read_b32 v54, v64 offset:17664
  ds_read_b32 v55, v64 offset:17792
  ds_read_b32 v56, v64 offset:17920
  ds_read_b32 v57, v64 offset:18048
  ds_read_b32 v58, v64 offset:18176
  ds_read_b32 v59, v64 offset:18304
  s_lshl_b32 s68, s55, 5
  s_lshl_b32 s67, s56, 3
  s_add_u32 s68, s68, s67
  s_add_u32 s67, s69, 8192
  s_lshl_b32 s62, s57, 13
  s_lshl_b32 s63, s56, 11
  s_add_u32 s62, s62, s63
  v_lshlrev_b32 v1, 4, v2
  v_add_u32 v5, s62, v1
  s_waitcnt lgkmcnt(0)
  v_perm_b32 v198, v53, v52, s80
  v_perm_b32 v199, v55, v54, s80
  v_perm_b32 v200, v57, v56, s80
  v_perm_b32 v201, v59, v58, s80
  buffer_store_dwordx4 v[198:201], v6, s[44:47], s71 offen sc1
  v_perm_b32 v202, v53, v52, s81
  v_perm_b32 v203, v55, v54, s81
  v_perm_b32 v204, v57, v56, s81
  v_perm_b32 v205, v59, v58, s81
  buffer_store_dwordx4 v[202:205], v6, s[44:47], s72 offen sc1
  global_load_dwordx4 v[80:83], v5, s[26:27]
  global_load_dwordx4 v[84:87], v5, s[26:27] offset:1024
  v_cmp_eq_u32 vcc, 0, v0
  s_mov_b32 s66, 0x07060100
  s_waitcnt vmcnt(8)
  v_cndmask_b32 v12, v12, 0, vcc
  v_cndmask_b32 v13, v13, 0, vcc
  v_cndmask_b32 v18, v18, 0, vcc
  v_cndmask_b32 v19, v19, 0, vcc
  v_alignbit_b32 v96, v17, v17, 16
  v_alignbit_b32 v97, v16, v16, 16
  v_alignbit_b32 v98, v15, v15, 16
  v_alignbit_b32 v99, v14, v14, 16
  v_perm_b32 v100, v16, v17, s66
  v_perm_b32 v101, v15, v16, s66
  v_perm_b32 v102, v14, v15, s66
  v_perm_b32 v103, v13, v14, s66
  v_alignbit_b32 v104, v16, v16, 16
  v_alignbit_b32 v105, v15, v15, 16
  v_alignbit_b32 v106, v14, v14, 16
  v_alignbit_b32 v107, v13, v13, 16
  v_perm_b32 v108, v15, v16, s66
  v_perm_b32 v109, v14, v15, s66
  v_perm_b32 v110, v13, v14, s66
  v_perm_b32 v111, v12, v13, s66
  ds_write_b128 v66, v[96:99] offset:17408
  ds_write_b128 v66, v[100:103] offset:21568
  ds_write_b128 v66, v[104:107] offset:25728
  ds_write_b128 v66, v[108:111] offset:29888
  v_alignbit_b32 v112, v23, v23, 16
  v_alignbit_b32 v113, v22, v22, 16
  v_alignbit_b32 v114, v21, v21, 16
  v_alignbit_b32 v115, v20, v20, 16
  v_perm_b32 v116, v22, v23, s66
  v_perm_b32 v117, v21, v22, s66
  v_perm_b32 v118, v20, v21, s66
  v_perm_b32 v119, v19, v20, s66
  v_alignbit_b32 v120, v22, v22, 16
  v_alignbit_b32 v121, v21, v21, 16
  v_alignbit_b32 v122, v20, v20, 16
  v_alignbit_b32 v123, v19, v19, 16
  v_perm_b32 v124, v21, v22, s66
  v_perm_b32 v125, v20, v21, s66
  v_perm_b32 v126, v19, v20, s66
  v_perm_b32 v127, v18, v19, s66
  ds_write_b128 v66, v[112:115] offset:34048
  ds_write_b128 v66, v[116:119] offset:38208
  ds_write_b128 v66, v[120:123] offset:42368
  ds_write_b128 v66, v[124:127] offset:46528
  s_waitcnt vmcnt(6)
  s_mov_b32 s6, 0
L_tokc:
  v_readfirstlane_b32 s4, v60
  v_readfirstlane_b32 s5, v61
  s_cmp_lg_u32 s4, 0
  s_cbranch_scc1 L_tokokc
  buffer_load_dwordx2 v[60:61], v62, s[48:51], 0 offen sc1
  s_waitcnt vmcnt(0)
  s_add_u32 s6, s6, 1
  s_cmp_lt_u32 s6, 1048576
  s_cbranch_scc1 L_tokc
L_tokokc:
  s_getreg_b32 s2, hwreg(HW_REG_XCC_ID, 0, 3)
  s_or_b32 s2, s2, s4
  s_mov_b32 s3, s5
  s_waitcnt vmcnt(2)
  s_mov_b64 exec, 1
  v_mov_b32 v8, s2
  v_mov_b32 v9, s3
  v_mov_b32 v10, s68
  buffer_store_dwordx2 v[8:9], v10, s[44:47], s69 offen
  s_mov_b64 exec, -1
  s_waitcnt lgkmcnt(0)
  s_barrier
  v_and_b32 v76, 3, v0
  v_sub_u32 v76, 3, v76
  v_mul_u32_u24 v76, 4160, v76
  v_and_b32 v77, 12, v0
  v_lshlrev_b32 v77, 1, v77
  v_sub_u32 v76, v76, v77
  v_and_b32 v77, 48, v0
  v_add_u32 v76, v76, v77
  s_lshr_b32 s60, s56, 1
  s_mul_i32 s60, s60, 16640
  s_and_b32 s61, s56, 1
  s_lshl_b32 s61, s61, 6
  s_sub_u32 s60, s60, s61
  s_add_u32 s60, s60, 17496
  v_add_u32 v76, s60, v76
  ds_read_b64 v[128:129], v76 offset:3968
  ds_read_b64 v[130:131], v76 offset:3976
  ds_read_b64 v[132:133], v76 offset:3840
  ds_read_b64 v[134:135], v76 offset:3848
  ds_read_b64 v[136:137], v76 offset:3712
  ds_read_b64 v[138:139], v76 offset:3720
  ds_read_b64 v[140:141], v76 offset:3584
  ds_read_b64 v[142:143], v76 offset:3592
  ds_read_b64 v[144:145], v76 offset:3456
  ds_read_b64 v[146:147], v76 offset:3464
  ds_read_b64 v[148:149], v76 offset:3328
  ds_read_b64 v[150:151], v76 offset:3336
  ds_read_b64 v[152:153], v76 offset:3200
  ds_read_b64 v[154:155], v76 offset:3208
  ds_read_b64 v[156:157], v76 offset:3072
  ds_read_b64 v[158:159], v76 offset:3080
  ds_read_b64 v[160:161], v76 offset:2944
  ds_read_b64 v[162:163], v76 offset:2952
  ds_read_b64 v[164:165], v76 offset:2816
  ds_read_b64 v[166:167], v76 offset:2824
  ds_read_b64 v[168:169], v76 offset:2688
  ds_read_b64 v[170:171], v76 offset:2696
  ds_read_b64 v[172:173], v76 offset:2560
  ds_read_b64 v[174:175], v76 offset:2568
  ds_read_b64 v[176:177], v76 offset:2432
  ds_read_b64 v[178:179], v76 offset:2440
  ds_read_b64 v[180:181], v76 offset:2304
  ds_read_b64 v[182:183], v76 offset:2312
  ds_read_b64 v[184:185], v76 offset:2176
  ds_read_b64 v[186:187], v76 offset:2184
  ds_read_b64 v[188:189], v76 offset:2048
  ds_read_b64 v[190:191], v76 offset:2056
  ds_read_b64 v[192:193], v76 offset:1920
  ds_read_b64 v[194:195], v76 offset:1928
  ds_read_b64 v[196:197], v76 offset:1792
  ds_read_b64 v[198:199], v76 offset:1800
  ds_read_b64 v[200:201], v76 offset:1664
  ds_read_b64 v[202:203], v76 offset:1672
  ds_read_b64 v[204:205], v76 offset:1536
  ds_read_b64 v[206:207], v76 offset:1544
  ds_read_b64 v[208:209], v76 offset:1408
  ds_read_b64 v[210:211], v76 offset:1416
  ds_read_b64 v[212:213], v76 offset:1280
  ds_read_b64 v[214:215], v76 offset:1288
  ds_read_b64 v[216:217], v76 offset:1152
  ds_read_b64 v[218:219], v76 offset:1160
  ds_read_b64 v[220:221], v76 offset:1024
  ds_read_b64 v[222:223], v76 offset:1032
  ds_read_b64 v[224:225], v76 offset:896
  ds_read_b64 v[226:227], v76 offset:904
  ds_read_b64 v[228:229], v76 offset:768
  ds_read_b64 v[230:231], v76 offset:776
  ds_read_b64 v[232:233], v76 offset:640
  ds_read_b64 v[234:235], v76 offset:648
  ds_read_b64 v[236:237], v76 offset:512
  ds_read_b64 v[238:239], v76 offset:520
  ds_read_b64 v[240:241], v76 offset:384
  ds_read_b64 v[242:243], v76 offset:392
  ds_read_b64 v[244:245], v76 offset:256
  ds_read_b64 v[246:247], v76 offset:264
  ds_read_b64 v[248:249], v76 offset:128
  ds_read_b64 v[250:251], v76 offset:136
  ds_read_b64 v[252:253], v76 offset:0
  ds_read_b64 v[254:255], v76 offset:8
  buffer_load_dwordx4 v[8:11], v1, s[44:47], s69 offen offset:0 sc1
  s_waitcnt vmcnt(2)
  v_mov_b32 v72, 0x3f803f80
  v_mov_b32 v68, 0
  v_mov_b32 v69, 0
  v_mov_b32 v70, 0
  v_mov_b32 v71, 0
  v_dot2_f32_bf16 v68, v80, v72, v68
  v_dot2_f32_bf16 v69, v80, v80, v69
  v_dot2_f32_bf16 v70, v84, v72, v70
  v_dot2_f32_bf16 v71, v84, v84, v71
  v_dot2_f32_bf16 v68, v81, v72, v68
  v_dot2_f32_bf16 v69, v81, v81, v69
  v_dot2_f32_bf16 v70, v85, v72, v70
  v_dot2_f32_bf16 v71, v85, v85, v71
  v_dot2_f32_bf16 v68, v82, v72, v68
  v_dot2_f32_bf16 v69, v82, v82, v69
  v_dot2_f32_bf16 v70, v86, v72, v70
  v_dot2_f32_bf16 v71, v86, v86, v71
  v_dot2_f32_bf16 v68, v83, v72, v68
  v_dot2_f32_bf16 v69, v83, v83, v69
  v_dot2_f32_bf16 v70, v87, v72, v70
  v_dot2_f32_bf16 v71, v87, v87, v71
  s_lshl_b32 s62, s57, 6
  s_lshl_b32 s63, s56, 4
  s_add_u32 s62, s62, s63
  v_add_f32_dpp v68, v68, v68 row_shr:1 row_mask:0xf bank_mask:0xf bound_ctrl:0
  v_add_f32_dpp v69, v69, v69 row_shr:1 row_mask:0xf bank_mask:0xf bound_ctrl:0
  v_add_f32_dpp v70, v70, v70 row_shr:1 row_mask:0xf bank_mask:0xf bound_ctrl:0
  v_add_f32_dpp v71, v71, v71 row_shr:1 row_mask:0xf bank_mask:0xf bound_ctrl:0
  v_add_f32_dpp v68, v68, v68 row_shr:2 row_mask:0xf bank_mask:0xf bound_ctrl:0
  v_add_f32_dpp v69, v69, v69 row_shr:2 row_mask:0xf bank_mask:0xf bound_ctrl:0
  v_add_f32_dpp v70, v70, v70 row_shr:2 row_mask:0xf bank_mask:0xf bound_ctrl:0
  v_add_f32_dpp v71, v71, v71 row_shr:2 row_mask:0xf bank_mask:0xf bound_ctrl:0
  v_add_f32_dpp v68, v68, v68 row_shr:4 row_mask:0xf bank_mask:0xf bound_ctrl:0
  v_add_f32_dpp v69, v69, v69 row_shr:4 row_mask:0xf bank_mask:0xf bound_ctrl:0
  v_add_f32_dpp v70, v70, v70 row_shr:4 row_mask:0xf bank_mask:0xf bound_ctrl:0
  v_add_f32_dpp v71, v71, v71 row_shr:4 row_mask:0xf bank_mask:0xf bound_ctrl:0
  v_add_f32_dpp v68, v68, v68 row_shr:8 row_mask:0xf bank_mask:0xf bound_ctrl:0
  v_add_f32_dpp v69, v69, v69 row_shr:8 row_mask:0xf bank_mask:0xf bound_ctrl:0
  v_add_f32_dpp v70, v70, v70 row_shr:8 row_mask:0xf bank_mask:0xf bound_ctrl:0
  v_add_f32_dpp v71, v71, v71 row_shr:8 row_mask:0xf bank_mask:0xf bound_ctrl:0
  v_add_f32_dpp v68, v68, v68 row_bcast:15 row_mask:0xa bank_mask:0xf
  v_add_f32_dpp v69, v69, v69 row_bcast:15 row_mask:0xa bank_mask:0xf
  v_add_f32_dpp v70, v70, v70 row_bcast:15 row_mask:0xa bank_mask:0xf
  v_add_f32_dpp v71, v71, v71 row_bcast:15 row_mask:0xa bank_mask:0xf
  v_add_f32_dpp v68, v68, v68 row_bcast:31 row_mask:0xc bank_mask:0xf
  v_add_f32_dpp v69, v69, v69 row_bcast:31 row_mask:0xc bank_mask:0xf
  v_add_f32_dpp v70, v70, v70 row_bcast:31 row_mask:0xc bank_mask:0xf
  v_add_f32_dpp v71, v71, v71 row_bcast:31 row_mask:0xc bank_mask:0xf
  v_mul_f32 v68, 0x3b000000, v68
  v_mul_f32 v69, 0x3b000000, v69
  v_fma_f32 v69, -v68, v68, v69
  v_max_f32 v69, 0, v69
  v_add_f32 v69, 0x3727c5ac, v69
  v_rsq_f32 v69, v69
  v_mul_f32 v70, 0x3b000000, v70
  v_mul_f32 v71, 0x3b000000, v71
  v_fma_f32 v71, -v70, v70, v71
  v_max_f32 v71, 0, v71
  v_add_f32 v71, 0x3727c5ac, v71
  v_rsq_f32 v71, v71
  v_mov_b32 v73, v60
  v_mov_b32 v75, v60
  v_cvt_pk_bf16_f32 v72, v68, v69
  v_cvt_pk_bf16_f32 v74, v70, v71
  s_mov_b32 exec_lo, 0
  s_mov_b32 exec_hi, 0x80000000
  buffer_store_dwordx4 v[72:75], v62, s[44:47], s62 offen offset:0 sc1
  s_mov_b64 exec, -1
  s_movk_i32 s65, 5958
  s_movk_i32 s66, 2752
  v_add_u32 v91, 0, v2
  v_mul_lo_u32 v92, v91, s65
  v_lshrrev_b32 v92, 16, v92
  v_mul_u32_u24 v93, 11, v92
  v_sub_u32 v91, v91, v93
  v_mul_lo_u32 v92, v92, s66
  v_lshl_add_u32 v91, v91, 4, v92
  v_accvgpr_write_b32 a192, v91
  v_mov_b32 v16, v91
  v_add_u32 v91, 64, v2
  v_mul_lo_u32 v92, v91, s65
  v_lshrrev_b32 v92, 16, v92
  v_mul_u32_u24 v93, 11, v92
  v_sub_u32 v91, v91, v93
  v_mul_lo_u32 v92, v92, s66
  v_lshl_add_u32 v91, v91, 4, v92
  v_subrev_u32 v91, 1024, v91
  v_accvgpr_write_b32 a193, v91
  v_mov_b32 v17, v91
  v_add_u32 v91, 128, v2
  v_mul_lo_u32 v92, v91, s65
  v_lshrrev_b32 v92, 16, v92
  v_mul_u32_u24 v93, 11, v92
  v_sub_u32 v91, v91, v93
  v_mul_lo_u32 v92, v92, s66
  v_lshl_add_u32 v91, v91, 4, v92
  v_subrev_u32 v91, 2048, v91
  v_accvgpr_write_b32 a194, v91
  v_mov_b32 v18, v91
  v_add_u32 v91, 192, v2
  v_mul_lo_u32 v92, v91, s65
  v_lshrrev_b32 v92, 16, v92
  v_mul_u32_u24 v93, 11, v92
  v_sub_u32 v91, v91, v93
  v_mul_lo_u32 v92, v92, s66
  v_lshl_add_u32 v91, v91, 4, v92
  v_subrev_u32 v91, 3072, v91
  v_accvgpr_write_b32 a195, v91
  v_mov_b32 v19, v91
  v_add_u32 v91, 256, v2
  v_mul_lo_u32 v92, v91, s65
  v_lshrrev_b32 v92, 16, v92
  v_mul_u32_u24 v93, 11, v92
  v_sub_u32 v91, v91, v93
  v_mul_lo_u32 v92, v92, s66
  v_lshl_add_u32 v91, v91, 4, v92
  v_accvgpr_write_b32 a196, v91
  v_mov_b32 v20, v91
  v_add_u32 v91, 320, v2
  v_mul_lo_u32 v92, v91, s65
  v_lshrrev_b32 v92, 16, v92
  v_mul_u32_u24 v93, 11, v92
  v_sub_u32 v91, v91, v93
  v_mul_lo_u32 v92, v92, s66
  v_lshl_add_u32 v91, v91, 4, v92
  v_subrev_u32 v91, 1024, v91
  v_accvgpr_write_b32 a197, v91
  v_mov_b32 v21, v91
  v_add_u32 v91, 384, v2
  v_mul_lo_u32 v92, v91, s65
  v_lshrrev_b32 v92, 16, v92
  v_mul_u32_u24 v93, 11, v92
  v_sub_u32 v91, v91, v93
  v_mul_lo_u32 v92, v92, s66
  v_lshl_add_u32 v91, v91, 4, v92
  v_subrev_u32 v91, 2048, v91
  v_accvgpr_write_b32 a198, v91
  v_mov_b32 v22, v91
  v_add_u32 v91, 448, v2
  v_mul_lo_u32 v92, v91, s65
  v_lshrrev_b32 v92, 16, v92
  v_mul_u32_u24 v93, 11, v92
  v_sub_u32 v91, v91, v93
  v_mul_lo_u32 v92, v92, s66
  v_lshl_add_u32 v91, v91, 4, v92
  v_subrev_u32 v91, 3072, v91
  v_accvgpr_write_b32 a199, v91
  v_mov_b32 v23, v91
  v_add_u32 v91, 512, v2
  v_mul_lo_u32 v92, v91, s65
  v_lshrrev_b32 v92, 16, v92
  v_mul_u32_u24 v93, 11, v92
  v_sub_u32 v91, v91, v93
  v_mul_lo_u32 v92, v92, s66
  v_lshl_add_u32 v91, v91, 4, v92
  v_accvgpr_write_b32 a200, v91
  v_mov_b32 v24, v91
  v_add_u32 v91, 576, v2
  v_mul_lo_u32 v92, v91, s65
  v_lshrrev_b32 v92, 16, v92
  v_mul_u32_u24 v93, 11, v92
  v_sub_u32 v91, v91, v93
  v_mul_lo_u32 v92, v92, s66
  v_lshl_add_u32 v91, v91, 4, v92
  v_subrev_u32 v91, 1024, v91
  v_accvgpr_write_b32 a201, v91
  v_mov_b32 v25, v91
  v_add_u32 v91, 640, v2
  v_mul_lo_u32 v92, v91, s65
  v_lshrrev_b32 v92, 16, v92
  v_mul_u32_u24 v93, 11, v92
  v_sub_u32 v91, v91, v93
  v_mul_lo_u32 v92, v92, s66
  v_lshl_add_u32 v91, v91, 4, v92
  v_subrev_u32 v91, 2048, v91
  v_accvgpr_write_b32 a202, v91
  v_mov_b32 v26, v91
  s_mul_i32 s16, s59, 172
  s_lshr_b32 s65, s56, 1
  s_mul_i32 s17, s65, 22560
  s_and_b32 s66, s56, 1
  s_mul_i32 s66, s66, 11280
  s_add_u32 s17, s17, s66
  s_lshr_b32 s25, s55, 4
  s_lshl_b32 s25, s25, 2
  s_add_u32 s25, s25, s54
  s_and_b32 s66, s55, 0
  s_lshl_b32 s66, s66, 1
  s_add_u32 s25, s25, s66
  s_and_b32 s25, s25, 7
  s_add_u32 s8, s25, s65
  s_mov_b64 exec, -1
  s_mov_b32 s6, 0
  s_waitcnt vmcnt(1)
  s_branch L_pchk1
L_poll1:
  buffer_load_dwordx4 v[8:11], v1, s[44:47], s69 offen offset:0 sc1
  s_waitcnt vmcnt(0)
L_pchk1:
  v_cmp_ne_u64 vcc, s[2:3], v[8:9]
  v_cmp_ne_u64 s[62:63], s[2:3], v[10:11]
  s_or_b64 vcc, vcc, s[62:63]
  s_cbranch_vccz L_pdone1
  s_add_u32 s6, s6, 1
  s_cmp_lg_u32 s6, 40
  s_cbranch_scc1 L_poll1
  buffer_wbl2 sc1
  s_waitcnt vmcnt(0)
  s_mov_b64 exec, 1
  v_mov_b32 v8, s4
  v_mov_b32 v9, s5
  v_mov_b32 v10, s68
  buffer_store_dwordx2 v[8:9], v10, s[44:47], s67 offen sc1
  s_mov_b64 exec, -1
L_slow1:
  buffer_load_dwordx4 v[8:11], v1, s[44:47], s69 offen offset:0 sc1
  buffer_load_dwordx4 v[12:15], v1, s[44:47], s67 offen offset:0 sc1
  s_waitcnt vmcnt(0)
  v_cmp_ne_u64 s[60:61], s[2:3], v[8:9]
  v_cmp_ne_u64 vcc, s[4:5], v[12:13]
  s_and_b64 vcc, vcc, s[60:61]
  v_cmp_ne_u64 s[60:61], s[2:3], v[10:11]
  v_cmp_ne_u64 s[62:63], s[4:5], v[14:15]
  s_and_b64 s[60:61], s[60:61], s[62:63]
  s_or_b64 vcc, vcc, s[60:61]
  s_add_u32 s6, s6, 1
  s_cbranch_vccz L_sdone1
  s_cmp_lt_u32 s6, 1048576
  s_cbranch_scc1 L_slow1
L_sdone1:
  buffer_inv sc1
  s_waitcnt vmcnt(0)
L_pdone1:
  s_mov_b64 exec, -1
  s_lshl_b32 s60, s55, 14
  s_add_u32 s60, s60, s22
  s_lshl_b32 s61, s56, 11
  s_add_u32 s60, s60, s61
  s_lshr_b32 s62, s56, 1
  s_mul_i32 s62, s62, 512
  s_add_u32 s62, s62, s61
  s_add_u32 m0, s62, 512
  s_add_u32 s63, s60, 8192
  buffer_load_dwordx4 v1, s[44:47], s60 offen sc1  lds
  buffer_load_dwordx4 v1, s[44:47], s60 offen offset:1024 sc1  lds
  s_add_u32 m0, s61, 9216
  s_nop 0
  buffer_load_dwordx4 v1, s[44:47], s63 offen sc1  lds
  buffer_load_dwordx4 v1, s[44:47], s63 offen offset:1024 sc1  lds
  v_and_b32 v2, 15, v0
  v_lshlrev_b32 v2, 5, v2
  v_and_b32 v9, 48, v0
  v_add_u32 v2, v2, v9
  s_lshr_b32 s60, s56, 1
  s_mul_i32 s60, s60, 4608
  s_and_b32 s61, s56, 1
  s_lshl_b32 s61, s61, 6
  s_sub_u32 s60, s60, s61
  s_add_u32 s60, s60, 96
  v_add_u32 v2, s60, v2
  v_lshlrev_b32 v13, 4, v0
  v_lshlrev_b32 v14, 6, v0
  s_lshl_b32 s11, s56, 12
  s_add_u32 s19, s11, 0
  s_add_u32 s11, s11, 50752
  v_and_b32 v12, 63, v0
  v_lshlrev_b32 v12, 4, v12
  s_getpc_b64 s[20:21]
L_pc2:
  s_and_b32 s60, s55, 3
  s_lshl_b32 s60, s60, 13
  s_add_u32 s60, s60, 2048
  v_lshl_add_u32 v15, v0, 5, s60
  v_min_u32 v15, L_end-L_pc2, v15
  s_add_u32 s18, s8, 0
  s_and_b32 s18, s18, 7
  s_mul_i32 s18, s18, 176128
  s_add_u32 s18, s18, s16
  s_add_u32 m0, s17, 73600
  s_nop 0
  buffer_load_dwordx4 v16, s[12:15], s18 offen offset:0 lds
  buffer_load_dwordx4 v17, s[12:15], s18 offen offset:1024 lds
  buffer_load_dwordx4 v18, s[12:15], s18 offen offset:2048 lds
  buffer_load_dwordx4 v19, s[12:15], s18 offen offset:3072 lds
  s_add_u32 m0, s17, 77696
  s_nop 0
  buffer_load_dwordx4 v20, s[12:15], s18 offen offset:0 lds
  buffer_load_dwordx4 v21, s[12:15], s18 offen offset:1024 lds
  s_waitcnt vmcnt(6) lgkmcnt(0)
  s_barrier
  ds_read_b128 v[80:83], v2 offset:0
  ds_read_b128 v[84:87], v2 offset:128
  ds_read_b128 v[88:91], v2 offset:256
  s_waitcnt lgkmcnt(2)
  v_mfma_f32_16x16x32_bf16 v[124:127], v[252:255], v[80:83], 0
  ds_read_b128 v[92:95], v2 offset:384
  global_load_dword a255, v15, s[20:21]
  v_mfma_f32_16x16x32_bf16 v[120:123], v[236:239], v[80:83], 0
  v_mfma_f32_16x16x32_bf16 v[116:119], v[220:223], v[80:83], 0
  v_bfe_u32 v9, v0, 4, 2
  v_lshlrev_b32 v9, 3, v9
  v_mfma_f32_16x16x32_bf16 v[112:115], v[204:207], v[80:83], 0
  v_bfe_u32 v10, v0, 2, 2
  v_lshl_add_u32 v9, v10, 1, v9
  v_mfma_f32_16x16x32_bf16 v[108:111], v[188:191], v[80:83], 0
  v_mul_u32_u24 v9, 176, v9
  v_mfma_f32_16x16x32_bf16 v[104:107], v[172:175], v[80:83], 0
  s_mul_i32 s60, s56, 48
  v_add_u32 v9, s60, v9
  v_and_b32 v10, 3, v0
  v_mfma_f32_16x16x32_bf16 v[100:103], v[156:159], v[80:83], 0
  v_lshl_add_u32 v3, v10, 3, v9
  v_bfe_u32 v10, v0, 1, 1
  v_mfma_f32_16x16x32_bf16 v[96:99], v[140:143], v[80:83], 0
  s_waitcnt lgkmcnt(2)
  v_lshl_add_u32 v9, v10, 3, v9
  v_and_b32 v10, 1, v0
  v_mfma_f32_16x16x32_bf16 v[124:127], v[248:251], v[84:87], v[124:127]
  ds_read_b128 v[80:83], v2 offset:512
  v_mul_u32_u24 v10, 11280, v10
  v_mfma_f32_16x16x32_bf16 v[120:123], v[232:235], v[84:87], v[120:123]
  v_add3_u32 v4, v9, v10, 32
  v_and_b32 v9, 15, v0
  v_mfma_f32_16x16x32_bf16 v[116:119], v[216:219], v[84:87], v[116:119]
  v_lshrrev_b32 v10, 1, v9
  v_and_b32 v10, 3, v10
  v_mfma_f32_16x16x32_bf16 v[112:115], v[200:203], v[84:87], v[112:115]
  v_bfe_u32 v11, v0, 4, 2
  v_xor_b32 v10, v10, v11
  v_mfma_f32_16x16x32_bf16 v[108:111], v[184:187], v[84:87], v[108:111]
  v_lshlrev_b32 v10, 4, v10
  v_lshl_add_u32 v9, v9, 6, v10
  v_mfma_f32_16x16x32_bf16 v[104:107], v[168:171], v[84:87], v[104:107]
  s_lshl_b32 s60, s56, 13
  v_add_u32 v5, s60, v9
  v_bfe_u32 v10, v0, 1, 4
  v_mfma_f32_16x16x32_bf16 v[100:103], v[152:155], v[84:87], v[100:103]
  v_bfe_u32 v11, v0, 2, 2
  v_and_b32 v1, 1, v0
  v_mfma_f32_16x16x32_bf16 v[96:99], v[136:139], v[84:87], v[96:99]
  s_waitcnt lgkmcnt(2)
  v_lshlrev_b32 v1, 1, v1
  v_xor_b32 v11, v11, v1
  v_mfma_f32_16x16x32_bf16 v[124:127], v[244:247], v[88:91], v[124:127]
  ds_read_b128 v[84:87], v2 offset:640
  v_lshlrev_b32 v11, 4, v11
  v_mfma_f32_16x16x32_bf16 v[120:123], v[228:231], v[88:91], v[120:123]
  v_lshl_add_u32 v10, v10, 6, v11
  v_lshrrev_b32 v11, 5, v0
  v_mfma_f32_16x16x32_bf16 v[116:119], v[212:215], v[88:91], v[116:119]
  v_lshl_add_u32 v6, v11, 10, v10
  v_xor_b32 v7, 16, v6
  v_mfma_f32_16x16x32_bf16 v[112:115], v[196:199], v[88:91], v[112:115]
  s_lshl_b32 s61, s54, 6
  s_lshl_b32 s62, s55, 1
  s_add_u32 s61, s61, s62
  s_lshr_b32 s62, s61, 2
  s_and_b32 s62, s62, 3
  s_lshl_b32 s62, s62, 1
  s_and_b32 s63, s61, 0x1f0
  s_lshr_b32 s64, s61, 1
  s_and_b32 s64, s64, 7
  s_add_u32 s63, s63, s64
  s_lshl_b32 s63, s63, 7
  s_add_u32 s63, s63, 1048576
  v_and_b32 v1, 7, v0
  v_xor_b32 v1, s62, v1
  v_mfma_f32_16x16x32_bf16 v[108:111], v[180:183], v[88:91], v[108:111]
  v_lshlrev_b32 v1, 4, v1
  v_lshrrev_b32 v9, 3, v0
  v_mfma_f32_16x16x32_bf16 v[104:107], v[164:167], v[88:91], v[104:107]
  v_lshl_add_u32 v8, v9, 16, v1
  v_mfma_f32_16x16x32_bf16 v[100:103], v[148:151], v[88:91], v[100:103]
  v_mfma_f32_16x16x32_bf16 v[96:99], v[132:135], v[88:91], v[96:99]
  s_waitcnt lgkmcnt(2)
  v_mfma_f32_16x16x32_bf16 v[124:127], v[240:243], v[92:95], v[124:127]
  ds_read_b128 v[88:91], v2 offset:768
  v_mfma_f32_16x16x32_bf16 v[120:123], v[224:227], v[92:95], v[120:123]
  v_mfma_f32_16x16x32_bf16 v[116:119], v[208:211], v[92:95], v[116:119]
  v_mfma_f32_16x16x32_bf16 v[112:115], v[192:195], v[92:95], v[112:115]
  v_mfma_f32_16x16x32_bf16 v[108:111], v[176:179], v[92:95], v[108:111]
  v_mfma_f32_16x16x32_bf16 v[104:107], v[160:163], v[92:95], v[104:107]
  v_mfma_f32_16x16x32_bf16 v[100:103], v[144:147], v[92:95], v[100:103]
  v_mfma_f32_16x16x32_bf16 v[96:99], v[128:131], v[92:95], v[96:99]
  s_waitcnt lgkmcnt(2)
  v_mfma_f32_16x16x32_bf16 v[124:127], v[236:239], v[80:83], v[124:127]
  ds_read_b128 v[92:95], v2 offset:896
  v_mfma_f32_16x16x32_bf16 v[120:123], v[220:223], v[80:83], v[120:123]
  ds_read_b128 v[248:251], v13 offset:9216
  ds_read_b128 v[252:255], v13 offset:13312
  v_mfma_f32_16x16x32_bf16 v[116:119], v[204:207], v[80:83], v[116:119]
  ds_read_b128 v[240:243], v13 offset:512
  ds_read_b128 v[244:247], v13 offset:5120
  v_mfma_f32_16x16x32_bf16 v[112:115], v[188:191], v[80:83], v[112:115]
  v_mfma_f32_16x16x32_bf16 v[108:111], v[172:175], v[80:83], v[108:111]
  v_mfma_f32_16x16x32_bf16 v[104:107], v[156:159], v[80:83], v[104:107]
  v_mfma_f32_16x16x32_bf16 v[100:103], v[140:143], v[80:83], v[100:103]
  s_waitcnt lgkmcnt(6)
  v_mfma_f32_16x16x32_bf16 v[124:127], v[232:235], v[84:87], v[124:127]
  ds_read_b128 v[80:83], v2 offset:1024
  v_mfma_f32_16x16x32_bf16 v[120:123], v[216:219], v[84:87], v[120:123]
  s_waitcnt lgkmcnt(4)
  ds_write_b128 v5, v[96:99] offset:17408
  v_lshlrev_b32 v32, 16, v248
  v_mfma_f32_16x16x32_bf16 v[116:119], v[200:203], v[84:87], v[116:119]
  v_and_b32 v33, s82, v248
  v_lshlrev_b32 v34, 16, v249
  v_mfma_f32_16x16x32_bf16 v[112:115], v[184:187], v[84:87], v[112:115]
  v_and_b32 v35, s82, v249
  v_lshlrev_b32 v36, 16, v250
  v_mfma_f32_16x16x32_bf16 v[108:111], v[168:171], v[84:87], v[108:111]
  v_and_b32 v37, s82, v250
  v_lshlrev_b32 v38, 16, v251
  v_mfma_f32_16x16x32_bf16 v[104:107], v[152:155], v[84:87], v[104:107]
  s_waitcnt lgkmcnt(4)
  v_and_b32 v39, s82, v251
  v_lshlrev_b32 v40, 16, v252
  v_mfma_f32_16x16x32_bf16 v[100:103], v[136:139], v[84:87], v[100:103]
  v_and_b32 v41, s82, v252
  v_lshlrev_b32 v42, 16, v253
  v_mfma_f32_16x16x32_bf16 v[124:127], v[228:231], v[88:91], v[124:127]
  ds_read_b128 v[84:87], v2 offset:1152
  v_and_b32 v43, s82, v253
  v_mfma_f32_16x16x32_bf16 v[120:123], v[212:215], v[88:91], v[120:123]
  v_lshlrev_b32 v44, 16, v254
  v_and_b32 v45, s82, v254
  v_mfma_f32_16x16x32_bf16 v[116:119], v[196:199], v[88:91], v[116:119]
  v_lshlrev_b32 v46, 16, v255
  v_and_b32 v47, s82, v255
  v_mfma_f32_16x16x32_bf16 v[112:115], v[180:183], v[88:91], v[112:115]
  v_mfma_f32_16x16x32_bf16 v[108:111], v[164:167], v[88:91], v[108:111]
  v_mfma_f32_16x16x32_bf16 v[104:107], v[148:151], v[88:91], v[104:107]
  v_mfma_f32_16x16x32_bf16 v[100:103], v[132:135], v[88:91], v[100:103]
  v_mfma_f32_16x16x32_bf16 v[124:127], v[224:227], v[92:95], v[124:127]
  ds_read_b128 v[88:91], v2 offset:1280
  v_mfma_f32_16x16x32_bf16 v[120:123], v[208:211], v[92:95], v[120:123]
  v_mfma_f32_16x16x32_bf16 v[116:119], v[192:195], v[92:95], v[116:119]
  v_mfma_f32_16x16x32_bf16 v[112:115], v[176:179], v[92:95], v[112:115]
  v_mfma_f32_16x16x32_bf16 v[108:111], v[160:163], v[92:95], v[108:111]
  v_accvgpr_read_b32 v228, a192
  v_accvgpr_read_b32 v229, a193
  v_mfma_f32_16x16x32_bf16 v[104:107], v[144:147], v[92:95], v[104:107]
  v_accvgpr_read_b32 v230, a194
  v_accvgpr_read_b32 v231, a195
  v_mfma_f32_16x16x32_bf16 v[100:103], v[128:131], v[92:95], v[100:103]
  s_waitcnt lgkmcnt(3)
  v_accvgpr_read_b32 v232, a196
  v_accvgpr_read_b32 v233, a197
  v_mfma_f32_16x16x32_bf16 v[124:127], v[220:223], v[80:83], v[124:127]
  ds_read_b128 v[92:95], v2 offset:1408
  v_mfma_f32_16x16x32_bf16 v[120:123], v[204:207], v[80:83], v[120:123]
  v_mfma_f32_16x16x32_bf16 v[116:119], v[188:191], v[80:83], v[116:119]
  v_mfma_f32_16x16x32_bf16 v[112:115], v[172:175], v[80:83], v[112:115]
  v_mfma_f32_16x16x32_bf16 v[108:111], v[156:159], v[80:83], v[108:111]
  v_mfma_f32_16x16x32_bf16 v[104:107], v[140:143], v[80:83], v[104:107]
  s_waitcnt lgkmcnt(2)
  ds_write_b128 v5, v[100:103] offset:18432
  v_mfma_f32_16x16x32_bf16 v[124:127], v[216:219], v[84:87], v[124:127]
  ds_read_b128 v[80:83], v2 offset:1536
  s_mov_b32 m0, s11
  s_nop 0
  buffer_load_dwordx4 v12, s[44:47], s19 offen offset:0 sc1 lds
  v_mfma_f32_16x16x32_bf16 v[120:123], v[200:203], v[84:87], v[120:123]
  buffer_load_dwordx4 v12, s[44:47], s19 offen offset:1024 sc1 lds
  buffer_load_dwordx4 v12, s[44:47], s19 offen offset:2048 sc1 lds
  v_mfma_f32_16x16x32_bf16 v[116:119], v[184:187], v[84:87], v[116:119]
  buffer_load_dwordx4 v12, s[44:47], s19 offen offset:3072 sc1 lds
  s_add_u32 m0, s17, 77696
  s_nop 0
  buffer_load_dwordx4 v22, s[12:15], s18 offen offset:2048 lds
  v_mfma_f32_16x16x32_bf16 v[112:115], v[168:171], v[84:87], v[112:115]
  buffer_load_dwordx4 v23, s[12:15], s18 offen offset:3072 lds
  s_add_u32 m0, s17, 81792
  s_nop 0
  buffer_load_dwordx4 v24, s[12:15], s18 offen offset:0 lds
  v_mfma_f32_16x16x32_bf16 v[108:111], v[152:155], v[84:87], v[108:111]
  buffer_load_dwordx4 v25, s[12:15], s18 offen offset:1024 lds
  buffer_load_dwordx4 v26, s[12:15], s18 offen offset:2048 lds
  v_mfma_f32_16x16x32_bf16 v[104:107], v[136:139], v[84:87], v[104:107]
  s_waitcnt lgkmcnt(3)
  v_mfma_f32_16x16x32_bf16 v[124:127], v[212:215], v[88:91], v[124:127]
  ds_read_b128 v[84:87], v2 offset:1664
  v_mfma_f32_16x16x32_bf16 v[120:123], v[196:199], v[88:91], v[120:123]
  v_mfma_f32_16x16x32_bf16 v[116:119], v[180:183], v[88:91], v[116:119]
  v_lshlrev_b32 v16, 16, v240
  v_and_b32 v17, s82, v240
  v_mfma_f32_16x16x32_bf16 v[112:115], v[164:167], v[88:91], v[112:115]
  v_lshlrev_b32 v18, 16, v241
  v_and_b32 v19, s82, v241
  v_mfma_f32_16x16x32_bf16 v[108:111], v[148:151], v[88:91], v[108:111]
  v_lshlrev_b32 v20, 16, v242
  v_and_b32 v21, s82, v242
  v_mfma_f32_16x16x32_bf16 v[104:107], v[132:135], v[88:91], v[104:107]
  s_waitcnt lgkmcnt(3)
  v_lshlrev_b32 v22, 16, v243
  v_and_b32 v23, s82, v243
  v_mfma_f32_16x16x32_bf16 v[124:127], v[208:211], v[92:95], v[124:127]
  ds_read_b128 v[88:91], v2 offset:1792
  v_lshlrev_b32 v24, 16, v244
  v_mfma_f32_16x16x32_bf16 v[120:123], v[192:195], v[92:95], v[120:123]
  v_and_b32 v25, s82, v244
  v_lshlrev_b32 v26, 16, v245
  v_mfma_f32_16x16x32_bf16 v[116:119], v[176:179], v[92:95], v[116:119]
  v_and_b32 v27, s82, v245
  v_lshlrev_b32 v28, 16, v246
  v_mfma_f32_16x16x32_bf16 v[112:115], v[160:163], v[92:95], v[112:115]
  v_and_b32 v29, s82, v246
  v_lshlrev_b32 v30, 16, v247
  v_mfma_f32_16x16x32_bf16 v[108:111], v[144:147], v[92:95], v[108:111]
  v_and_b32 v31, s82, v247
  v_mul_f32 v16, s78, v16
  v_mfma_f32_16x16x32_bf16 v[104:107], v[128:131], v[92:95], v[104:107]
  s_waitcnt lgkmcnt(2)
  v_mul_f32 v17, s78, v17
  v_mul_f32 v18, s78, v18
  v_mfma_f32_16x16x32_bf16 v[124:127], v[204:207], v[80:83], v[124:127]
  ds_read_b128 v[92:95], v2 offset:1920
  v_mul_f32 v19, s78, v19
  v_mfma_f32_16x16x32_bf16 v[120:123], v[188:191], v[80:83], v[120:123]
  v_mul_f32 v20, s78, v20
  v_mul_f32 v21, s78, v21
  v_mfma_f32_16x16x32_bf16 v[116:119], v[172:175], v[80:83], v[116:119]
  v_mul_f32 v22, s78, v22
  v_mul_f32 v23, s78, v23
  v_mfma_f32_16x16x32_bf16 v[112:115], v[156:159], v[80:83], v[112:115]
  v_mul_f32 v24, s79, v24
  v_mul_f32 v25, s79, v25
  v_mfma_f32_16x16x32_bf16 v[108:111], v[140:143], v[80:83], v[108:111]
  s_waitcnt lgkmcnt(2)
  v_mul_f32 v26, s79, v26
  v_mul_f32 v27, s79, v27
  v_mfma_f32_16x16x32_bf16 v[124:127], v[200:203], v[84:87], v[124:127]
  ds_read_b128 v[80:83], v2 offset:2048
  ds_write_b128 v5, v[104:107] offset:19456
  v_mfma_f32_16x16x32_bf16 v[120:123], v[184:187], v[84:87], v[120:123]
  v_mul_f32 v28, s79, v28
  v_mul_f32 v29, s79, v29
  v_mfma_f32_16x16x32_bf16 v[116:119], v[168:171], v[84:87], v[116:119]
  v_mul_f32 v30, s79, v30
  v_mul_f32 v31, s79, v31
  v_mfma_f32_16x16x32_bf16 v[112:115], v[152:155], v[84:87], v[112:115]
  v_mfma_f32_16x16x32_bf16 v[108:111], v[136:139], v[84:87], v[108:111]
  s_waitcnt lgkmcnt(3)
  v_mfma_f32_16x16x32_bf16 v[124:127], v[196:199], v[88:91], v[124:127]
  ds_read_b128 v[84:87], v2 offset:2176
  v_mfma_f32_16x16x32_bf16 v[120:123], v[180:183], v[88:91], v[120:123]
  v_mfma_f32_16x16x32_bf16 v[116:119], v[164:167], v[88:91], v[116:119]
  v_mfma_f32_16x16x32_bf16 v[112:115], v[148:151], v[88:91], v[112:115]
  v_mfma_f32_16x16x32_bf16 v[108:111], v[132:135], v[88:91], v[108:111]
  s_waitcnt lgkmcnt(3)
  v_mfma_f32_16x16x32_bf16 v[124:127], v[192:195], v[92:95], v[124:127]
  ds_read_b128 v[88:91], v2 offset:2304
  v_mfma_f32_16x16x32_bf16 v[120:123], v[176:179], v[92:95], v[120:123]
  v_mfma_f32_16x16x32_bf16 v[116:119], v[160:163], v[92:95], v[116:119]
  v_mfma_f32_16x16x32_bf16 v[112:115], v[144:147], v[92:95], v[112:115]
  s_waitcnt vmcnt(5)
  ds_read_b128 v[64:67], v14 offset:50752
  ds_read_b128 v[68:71], v14 offset:50768
  v_mfma_f32_16x16x32_bf16 v[108:111], v[128:131], v[92:95], v[108:111]
  s_waitcnt lgkmcnt(5)
  ds_read_b128 v[72:75], v14 offset:50784
  ds_read_b128 v[76:79], v14 offset:50800
  v_mfma_f32_16x16x32_bf16 v[124:127], v[188:191], v[80:83], v[124:127]
  ds_read_b128 v[92:95], v2 offset:2432
  v_mfma_f32_16x16x32_bf16 v[120:123], v[172:175], v[80:83], v[120:123]
  v_mfma_f32_16x16x32_bf16 v[116:119], v[156:159], v[80:83], v[116:119]
  v_mfma_f32_16x16x32_bf16 v[112:115], v[140:143], v[80:83], v[112:115]
  s_waitcnt lgkmcnt(6)
  v_mfma_f32_16x16x32_bf16 v[124:127], v[184:187], v[84:87], v[124:127]
  ds_read_b128 v[80:83], v2 offset:2560
  v_mfma_f32_16x16x32_bf16 v[120:123], v[168:171], v[84:87], v[120:123]
  ds_write_b128 v5, v[108:111] offset:20480
  v_mfma_f32_16x16x32_bf16 v[116:119], v[152:155], v[84:87], v[116:119]
  s_add_u32 s18, s8, 2
  s_and_b32 s18, s18, 7
  s_mul_i32 s18, s18, 176128
  s_add_u32 s18, s18, s16
  s_add_u32 m0, s17, 118720
  s_nop 0
  buffer_load_dwordx4 v228, s[12:15], s18 offen offset:0 lds
  buffer_load_dwordx4 v229, s[12:15], s18 offen offset:1024 lds
  v_mfma_f32_16x16x32_bf16 v[112:115], v[136:139], v[84:87], v[112:115]
  s_waitcnt lgkmcnt(7)
  buffer_load_dwordx4 v230, s[12:15], s18 offen offset:2048 lds
  buffer_load_dwordx4 v231, s[12:15], s18 offen offset:3072 lds
  s_add_u32 m0, s17, 122816
  s_nop 0
  v_mfma_f32_16x16x32_bf16 v[124:127], v[180:183], v[88:91], v[124:127]
  ds_read_b128 v[84:87], v2 offset:2688
  buffer_load_dwordx4 v232, s[12:15], s18 offen offset:0 lds
  v_mfma_f32_16x16x32_bf16 v[120:123], v[164:167], v[88:91], v[120:123]
  s_waitcnt lgkmcnt(6)
  buffer_load_dwordx4 v233, s[12:15], s18 offen offset:1024 lds
  v_min3_u32 v9, v65, v67, v69
  v_mfma_f32_16x16x32_bf16 v[116:119], v[148:151], v[88:91], v[116:119]
  s_waitcnt lgkmcnt(5)
  v_max3_u32 v10, v65, v67, v69
  v_min3_u32 v9, v9, v71, v73
  v_mfma_f32_16x16x32_bf16 v[112:115], v[132:135], v[88:91], v[112:115]
  s_waitcnt lgkmcnt(3)
  s_waitcnt lgkmcnt(4)
  v_max3_u32 v10, v10, v71, v73
  v_min3_u32 v9, v9, v75, v77
  v_mfma_f32_16x16x32_bf16 v[124:127], v[176:179], v[92:95], v[124:127]
  ds_read_b128 v[88:91], v2 offset:2816
  v_max3_u32 v10, v10, v75, v77
  v_mfma_f32_16x16x32_bf16 v[120:123], v[160:163], v[92:95], v[120:123]
  v_min_u32 v9, v9, v79
  v_max_u32 v10, v10, v79
  v_mfma_f32_16x16x32_bf16 v[116:119], v[144:147], v[92:95], v[116:119]
  v_cmp_ne_u32 s[68:69], s4, v9
  v_cmp_ne_u32 s[70:71], s4, v10
  v_mfma_f32_16x16x32_bf16 v[112:115], v[128:131], v[92:95], v[112:115]
  s_waitcnt lgkmcnt(3)
  v_lshlrev_b32 v65, 16, v64
  v_and_b32 v64, s82, v64
  v_mfma_f32_16x16x32_bf16 v[124:127], v[172:175], v[80:83], v[124:127]
  ds_read_b128 v[92:95], v2 offset:2944
  v_sub_f32 v48, v32, v65
  v_mfma_f32_16x16x32_bf16 v[120:123], v[156:159], v[80:83], v[120:123]
  v_sub_f32 v56, v40, v65
  v_mul_f32 v48, v48, v64
  v_mfma_f32_16x16x32_bf16 v[116:119], v[140:143], v[80:83], v[116:119]
  s_waitcnt lgkmcnt(2)
  v_mul_f32 v56, v56, v64
  v_lshlrev_b32 v67, 16, v66
  v_mfma_f32_16x16x32_bf16 v[124:127], v[168:171], v[84:87], v[124:127]
  ds_read_b128 v[80:83], v2 offset:3072
  v_and_b32 v66, s82, v66
  v_mfma_f32_16x16x32_bf16 v[120:123], v[152:155], v[84:87], v[120:123]
  v_sub_f32 v49, v33, v67
  v_sub_f32 v57, v41, v67
  v_mfma_f32_16x16x32_bf16 v[116:119], v[136:139], v[84:87], v[116:119]
  s_waitcnt lgkmcnt(2)
  ds_write_b128 v5, v[112:115] offset:21504
  v_mul_f32 v49, v49, v66
  v_mfma_f32_16x16x32_bf16 v[124:127], v[164:167], v[88:91], v[124:127]
  ds_read_b128 v[84:87], v2 offset:3200
  v_mul_f32 v57, v57, v66
  v_mfma_f32_16x16x32_bf16 v[120:123], v[148:151], v[88:91], v[120:123]
  v_lshlrev_b32 v69, 16, v68
  v_and_b32 v68, s82, v68
  v_mfma_f32_16x16x32_bf16 v[116:119], v[132:135], v[88:91], v[116:119]
  s_waitcnt lgkmcnt(3)
  v_sub_f32 v50, v34, v69
  v_sub_f32 v58, v42, v69
  v_mfma_f32_16x16x32_bf16 v[124:127], v[160:163], v[92:95], v[124:127]
  ds_read_b128 v[88:91], v2 offset:3328
  v_mul_f32 v50, v50, v68
  v_mfma_f32_16x16x32_bf16 v[120:123], v[144:147], v[92:95], v[120:123]
  v_mul_f32 v58, v58, v68
  v_lshlrev_b32 v71, 16, v70
  v_mfma_f32_16x16x32_bf16 v[116:119], v[128:131], v[92:95], v[116:119]
  s_waitcnt lgkmcnt(3)
  v_and_b32 v70, s82, v70
  v_sub_f32 v51, v35, v71
  v_mfma_f32_16x16x32_bf16 v[124:127], v[156:159], v[80:83], v[124:127]
  ds_read_b128 v[92:95], v2 offset:3456
  v_sub_f32 v59, v43, v71
  v_mfma_f32_16x16x32_bf16 v[120:123], v[140:143], v[80:83], v[120:123]
  s_waitcnt lgkmcnt(2)
  v_mul_f32 v51, v51, v70
  v_mul_f32 v59, v59, v70
  v_mfma_f32_16x16x32_bf16 v[124:127], v[152:155], v[84:87], v[124:127]
  ds_read_b128 v[80:83], v2 offset:3584
  v_lshlrev_b32 v73, 16, v72
  v_mfma_f32_16x16x32_bf16 v[120:123], v[136:139], v[84:87], v[120:123]
  s_waitcnt lgkmcnt(2)
  v_and_b32 v72, s82, v72
  v_sub_f32 v52, v36, v73
  v_mfma_f32_16x16x32_bf16 v[124:127], v[148:151], v[88:91], v[124:127]
  ds_read_b128 v[84:87], v2 offset:3712
  v_sub_f32 v60, v44, v73
  v_mfma_f32_16x16x32_bf16 v[120:123], v[132:135], v[88:91], v[120:123]
  s_waitcnt lgkmcnt(2)
  ds_write_b128 v5, v[116:119] offset:22528
  v_mul_f32 v52, v52, v72
  v_mfma_f32_16x16x32_bf16 v[124:127], v[144:147], v[92:95], v[124:127]
  ds_read_b128 v[88:91], v2 offset:3840
  v_mul_f32 v60, v60, v72
  v_mfma_f32_16x16x32_bf16 v[120:123], v[128:131], v[92:95], v[120:123]
  s_waitcnt lgkmcnt(3)
  v_lshlrev_b32 v75, 16, v74
  v_and_b32 v74, s82, v74
  v_mfma_f32_16x16x32_bf16 v[124:127], v[140:143], v[80:83], v[124:127]
  s_waitcnt lgkmcnt(2)
  ds_read_b128 v[92:95], v2 offset:3968
  v_sub_f32 v53, v37, v75
  v_mfma_f32_16x16x32_bf16 v[124:127], v[136:139], v[84:87], v[124:127]
  s_waitcnt lgkmcnt(1)
  v_sub_f32 v61, v45, v75
  v_mul_f32 v53, v53, v74
  v_mfma_f32_16x16x32_bf16 v[124:127], v[132:135], v[88:91], v[124:127]
  s_waitcnt lgkmcnt(0)
  v_mul_f32 v61, v61, v74
  v_lshlrev_b32 v77, 16, v76
  v_mfma_f32_16x16x32_bf16 v[124:127], v[128:131], v[92:95], v[124:127]
  v_and_b32 v76, s82, v76
  v_sub_f32 v54, v38, v77
  ds_write_b128 v5, v[120:123] offset:23552
  v_sub_f32 v62, v46, v77
  v_mul_f32 v54, v54, v76
  v_mul_f32 v62, v62, v76
  v_lshlrev_b32 v79, 16, v78
  v_and_b32 v78, s82, v78
  v_sub_f32 v55, v39, v79
  v_sub_f32 v63, v47, v79
  v_mul_f32 v55, v55, v78
  v_mul_f32 v63, v63, v78
  s_or_b64 s[70:71], s[70:71], s[68:69]
  s_cbranch_scc0 L_stok
  s_mov_b32 s6, 0
L_strp:
  s_mov_b32 m0, s11
  s_nop 0
  buffer_load_dwordx4 v12, s[44:47], s19 offen offset:0 sc1 lds
  buffer_load_dwordx4 v12, s[44:47], s19 offen offset:1024 sc1 lds
  buffer_load_dwordx4 v12, s[44:47], s19 offen offset:2048 sc1 lds
  buffer_load_dwordx4 v12, s[44:47], s19 offen offset:3072 sc1 lds
  s_waitcnt vmcnt(0)
  ds_read_b128 v[64:67], v14 offset:50752
  ds_read_b128 v[68:71], v14 offset:50768
  ds_read_b128 v[72:75], v14 offset:50784
  ds_read_b128 v[76:79], v14 offset:50800
  s_waitcnt lgkmcnt(0)
  v_min3_u32 v9, v65, v67, v69
  v_max3_u32 v10, v65, v67, v69
  v_min3_u32 v9, v9, v71, v73
  v_max3_u32 v10, v10, v71, v73
  v_min3_u32 v9, v9, v75, v77
  v_max3_u32 v10, v10, v75, v77
  v_min_u32 v9, v9, v79
  v_max_u32 v10, v10, v79
  v_cmp_ne_u32 s[68:69], s4, v9
  v_cmp_ne_u32 s[70:71], s4, v10
  s_nop 0
  s_or_b64 s[70:71], s[70:71], s[68:69]
  s_cbranch_scc0 L_strq
  s_add_u32 s6, s6, 1
  s_cmp_lt_u32 s6, 1048576
  s_cbranch_scc1 L_strp
L_strq:
  v_lshlrev_b32 v65, 16, v64
  v_and_b32 v64, s82, v64
  v_sub_f32 v48, v32, v65
  v_sub_f32 v56, v40, v65
  v_mul_f32 v48, v48, v64
  v_mul_f32 v56, v56, v64
  v_lshlrev_b32 v67, 16, v66
  v_and_b32 v66, s82, v66
  v_sub_f32 v49, v33, v67
  v_sub_f32 v57, v41, v67
  v_mul_f32 v49, v49, v66
  v_mul_f32 v57, v57, v66
  v_lshlrev_b32 v69, 16, v68
  v_and_b32 v68, s82, v68
  v_sub_f32 v50, v34, v69
  v_sub_f32 v58, v42, v69
  v_mul_f32 v50, v50, v68
  v_mul_f32 v58, v58, v68
  v_lshlrev_b32 v71, 16, v70
  v_and_b32 v70, s82, v70
  v_sub_f32 v51, v35, v71
  v_sub_f32 v59, v43, v71
  v_mul_f32 v51, v51, v70
  v_mul_f32 v59, v59, v70
  v_lshlrev_b32 v73, 16, v72
  v_and_b32 v72, s82, v72
  v_sub_f32 v52, v36, v73
  v_sub_f32 v60, v44, v73
  v_mul_f32 v52, v52, v72
  v_mul_f32 v60, v60, v72
  v_lshlrev_b32 v75, 16, v74
  v_and_b32 v74, s82, v74
  v_sub_f32 v53, v37, v75
  v_sub_f32 v61, v45, v75
  v_mul_f32 v53, v53, v74
  v_mul_f32 v61, v61, v74
  v_lshlrev_b32 v77, 16, v76
  v_and_b32 v76, s82, v76
  v_sub_f32 v54, v38, v77
  v_sub_f32 v62, v46, v77
  v_mul_f32 v54, v54, v76
  v_mul_f32 v62, v62, v76
  v_lshlrev_b32 v79, 16, v78
  v_and_b32 v78, s82, v78
  v_sub_f32 v55, v39, v79
  v_sub_f32 v63, v47, v79
  v_mul_f32 v55, v55, v78
  v_mul_f32 v63, v63, v78
L_stok:
  s_nop 3
  ds_write_b128 v5, v[124:127] offset:24576
  s_waitcnt lgkmcnt(0)
  s_barrier
  ds_read_b128 v[160:163], v6 offset:17408
  ds_read_b128 v[164:167], v7 offset:17408
  ds_read_b128 v[168:171], v6 offset:25600
  ds_read_b128 v[172:175], v7 offset:25600
  ds_read_b128 v[176:179], v6 offset:33792
  ds_read_b128 v[180:183], v7 offset:33792
  ds_read_b128 v[184:187], v6 offset:41984
  ds_read_b128 v[188:191], v7 offset:41984
  v_and_b32 v120, 63, v0
  v_mul_u32_u24 v120, 176, v120
  v_mov_b32 v143, 0x3f80
  s_add_u32 s60, s17, 172
  v_add_u32 v122, s60, v120
  v_add_u32 v120, 73600, v122
  s_waitcnt lgkmcnt(4)
  v_pk_add_f32 v[160:161], v[160:161], v[168:169]
  v_pk_add_f32 v[162:163], v[162:163], v[170:171]
  v_pk_add_f32 v[164:165], v[164:165], v[172:173]
  v_pk_add_f32 v[166:167], v[166:167], v[174:175]
  v_pk_add_f32 v[160:161], v[160:161], v[16:17]
  v_pk_add_f32 v[162:163], v[162:163], v[18:19]
  v_pk_add_f32 v[164:165], v[164:165], v[20:21]
  v_pk_add_f32 v[166:167], v[166:167], v[22:23]
  v_pk_fma_f32 v[160:161], v[160:161], v[48:49], v[32:33]
  v_pk_fma_f32 v[162:163], v[162:163], v[50:51], v[34:35]
  v_pk_fma_f32 v[164:165], v[164:165], v[52:53], v[36:37]
  v_pk_fma_f32 v[166:167], v[166:167], v[54:55], v[38:39]
  v_cvt_pk_bf16_f32 v168, v160, v161
  v_cvt_pk_bf16_f32 v169, v162, v163
  v_cvt_pk_bf16_f32 v170, v164, v165
  v_cvt_pk_bf16_f32 v171, v166, v167
  buffer_store_dwordx4 v[168:171], v8, s[44:47], s63 offen offset:0 sc1
  s_waitcnt lgkmcnt(0)
  v_pk_add_f32 v[176:177], v[176:177], v[184:185]
  v_pk_add_f32 v[178:179], v[178:179], v[186:187]
  v_pk_add_f32 v[180:181], v[180:181], v[188:189]
  v_pk_add_f32 v[182:183], v[182:183], v[190:191]
  v_pk_add_f32 v[176:177], v[176:177], v[24:25]
  v_pk_add_f32 v[178:179], v[178:179], v[26:27]
  v_pk_add_f32 v[180:181], v[180:181], v[28:29]
  v_pk_add_f32 v[182:183], v[182:183], v[30:31]
  v_pk_fma_f32 v[176:177], v[176:177], v[56:57], v[40:41]
  v_pk_fma_f32 v[178:179], v[178:179], v[58:59], v[42:43]
  v_pk_fma_f32 v[180:181], v[180:181], v[60:61], v[44:45]
  v_pk_fma_f32 v[182:183], v[182:183], v[62:63], v[46:47]
  v_cvt_pk_bf16_f32 v184, v176, v177
  v_cvt_pk_bf16_f32 v185, v178, v179
  v_cvt_pk_bf16_f32 v186, v180, v181
  v_cvt_pk_bf16_f32 v187, v182, v183
  buffer_store_dwordx4 v[184:187], v8, s[44:47], s63 offen offset:1024 sc1
  v_accvgpr_read_b32 v64, a192
  v_accvgpr_read_b32 v65, a193
  v_accvgpr_read_b32 v66, a194
  v_accvgpr_read_b32 v67, a195
  v_accvgpr_read_b32 v68, a196
  v_accvgpr_read_b32 v69, a197
  v_accvgpr_read_b32 v70, a198
  v_accvgpr_read_b32 v71, a199
  v_accvgpr_read_b32 v72, a200
  v_accvgpr_read_b32 v73, a201
  v_accvgpr_read_b32 v74, a202
  s_add_u32 s18, s8, 2
  s_and_b32 s18, s18, 7
  s_mul_i32 s18, s18, 176128
  s_add_u32 s18, s18, s16
  s_add_u32 m0, s17, 122816
  s_nop 0
  v_bfe_u32 v1, v0, 3, 3
  v_and_b32 v124, 7, v0
  v_bfe_u32 v125, v0, 4, 1
  v_lshlrev_b32 v125, 2, v125
  v_xor_b32 v124, v124, v125
  v_lshlrev_b32 v124, 4, v124
  v_lshl_add_u32 v124, v1, 10, v124
  v_bfe_u32 v1, v0, 5, 1
  v_lshlrev_b32 v1, 3, v1
  v_bfe_u32 v125, v0, 2, 2
  v_add_u32 v1, v1, v125
  v_lshlrev_b32 v1, 7, v1
  v_bfe_u32 v125, v0, 3, 1
  s_and_b32 s60, s56, 1
  v_xor_b32 v125, s60, v125
  v_lshl_add_u32 v1, v125, 6, v1
  v_bfe_u32 v125, v0, 4, 1
  v_lshl_add_u32 v1, v125, 5, v1
  v_and_b32 v125, 3, v0
  v_lshl_add_u32 v1, v125, 3, v1
  s_lshr_b32 s61, s56, 1
  s_lshl_b32 s62, s61, 11
  v_add_u32 v125, s62, v1
  s_and_b32 s7, s59, 7
  s_lshl_b32 s7, s7, 7
  s_mul_i32 s61, s61, 704512
  s_add_u32 s7, s7, s61
  s_lshl_b32 s60, s60, 13
  s_add_u32 s7, s7, s60
  s_lshr_b32 s60, s60, 2
  s_sub_u32 s74, s7, s60
  s_lshr_b32 s60, s55, 4
  s_mul_i32 s60, s60, 352256
  s_sub_u32 s9, s7, s60
  s_sub_u32 s10, s74, s60
  s_add_u32 s7, s7, s60
  s_add_u32 s74, s74, s60
  v_bfe_u32 v112, v0, 5, 1
  v_lshlrev_b32 v112, 4, v112
  v_bfe_u32 v113, v0, 2, 3
  v_add_u32 v112, v112, v113
  v_lshlrev_b32 v112, 7, v112
  v_bfe_u32 v113, v0, 3, 2
  v_lshl_add_u32 v112, v113, 5, v112
  v_and_b32 v113, 3, v0
  v_lshl_add_u32 v9, v113, 3, v112
  v_and_b32 v112, 15, v0
  v_add_u32 v15, 48, v112
  v_lshlrev_b32 v15, 2, v15
  v_lshlrev_b32 v112, 4, v112
  v_add_u32 v12, 131072, v112
  v_bfe_u32 v113, v0, 4, 2
  v_lshl_add_u32 v14, v113, 2, v112
  v_bfe_u32 v113, v0, 5, 1
  v_lshl_add_u32 v13, v113, 8, v112
  v_bfe_u32 v113, v0, 4, 1
  v_lshl_add_u32 v13, v113, 3, v13
  s_and_b32 s68, s58, 1
  s_mul_i32 s68, s68, 360448
  s_mul_i32 s69, s59, 2816
  s_add_u32 s68, s68, s69
  s_mul_i32 s69, s56, 768
  s_add_u32 s68, s68, s69
  s_add_u32 s68, s68, s22
  s_lshl_b32 s76, s58, 17
  s_add_u32 s76, s76, s24
  s_add_u32 s76, s76, 1048576
  s_mov_b32 s70, 0
  s_mov_b32 s71, 0xffff0000
  s_mov_b32 s72, 0xaaaaaaaa
  s_mov_b32 s73, 0xaaaaaaaa
  s_mov_b32 s78, 0xcccccccc
  s_mov_b32 s79, 0xcccccccc
  s_mov_b32 s80, 0xf0000f
  s_mov_b32 s81, 0xf0000f00
  v_and_b32 v1, 63, v0
  v_lshlrev_b32 v1, 4, v1
  v_lshlrev_b32 v127, 3, v1
  v_add_u32 v112, 42240, v127
  v_cmp_lt_u32 vcc, 2688, v127
  s_mul_i32 s60, s56, 89344
  s_add_u32 s60, s60, s68
  v_cndmask_b32 v127, v127, v112, vcc
  v_add_u32 v126, s76, v1
  v_add_u32 v43, 65536, v126
  s_lshl_b32 s61, s59, 13
  s_add_u32 s61, s61, s24
  s_add_u32 s61, s61, s76
  v_lshl_add_u32 v44, v1, 1, s61
  s_lshl_b32 s76, s25, 13
  v_add_u32 v127, s60, v127
  s_lshl_b32 s60, s58, 7
  s_add_u32 s60, s60, 86016
  v_writelane_b32 v127, s60, 44
  v_add_u32 v141, 2048, v12
  v_cndmask_b32 v141, v141, v12, s[80:81]
  v_mov_b32 v116, 0x3f803f80
  v_mov_b32 v117, 0x3f803f80
  v_mov_b32 v118, 0x3f803f80
  v_mov_b32 v119, 0x3f803f80
  s_lshl_b32 s64, s54, 31
  s_mov_b32 s64, 0
  s_add_u32 s64, s64, 98304
  s_lshl_b32 s65, s54, 8
  s_lshl_b32 s66, s55, 3
  s_add_u32 s65, s65, s66
  s_add_u32 s65, s65, 98304
  v_lshlrev_b32 v34, 7, v1
  v_mov_b32 v32, s4
  v_mov_b32 v33, s5
  s_waitcnt vmcnt(0)
  ds_write_b16 v120, v143 offset:0
  s_waitcnt lgkmcnt(0)
  s_barrier
  s_cmp_lg_u32 s56, 0
  s_cbranch_scc1 L_nofb
  s_mov_b64 exec, 1
  buffer_store_dwordx2 v[32:33], v34, s[44:47], s65 offen sc1
  s_mov_b64 exec, -1
L_nofb:
  buffer_load_dwordx4 v70, s[12:15], s18 offen offset:2048 lds
  buffer_load_dwordx4 v71, s[12:15], s18 offen offset:3072 lds
  s_add_u32 m0, s17, 126912
  s_nop 0
  buffer_load_dwordx4 v72, s[12:15], s18 offen offset:0 lds
  buffer_load_dwordx4 v73, s[12:15], s18 offen offset:1024 lds
  buffer_load_dwordx4 v74, s[12:15], s18 offen offset:2048 lds
  v_add_u32 v5, 73600, v3
  v_add_u32 v6, 73600, v4
  ds_read_b64_tr_b16 a[0:1], v5 offset:0
  ds_read_b64_tr_b16 a[2:3], v5 offset:176
  ds_read_b64_tr_b16 a[4:5], v5 offset:11280
  ds_read_b64_tr_b16 a[6:7], v5 offset:11456
  ds_read_b64_tr_b16 a[8:9], v6 offset:0
  ds_read_b64_tr_b16 a[10:11], v6 offset:176
  ds_read_b64_tr_b16 a[12:13], v5 offset:5632
  ds_read_b64_tr_b16 a[14:15], v5 offset:5808
  ds_read_b64_tr_b16 a[16:17], v5 offset:16912
  ds_read_b64_tr_b16 a[18:19], v5 offset:17088
  ds_read_b64_tr_b16 a[20:21], v6 offset:5632
  ds_read_b64_tr_b16 a[22:23], v6 offset:5808
  v_add_u32 v7, 96160, v3
  v_add_u32 v8, 96160, v4
  ds_read_b64_tr_b16 a[24:25], v7 offset:0
  ds_read_b64_tr_b16 a[26:27], v7 offset:176
  ds_read_b64_tr_b16 a[28:29], v7 offset:11280
  ds_read_b64_tr_b16 a[30:31], v7 offset:11456
  ds_read_b64_tr_b16 a[32:33], v8 offset:0
  ds_read_b64_tr_b16 a[34:35], v8 offset:176
  ds_read_b64_tr_b16 a[36:37], v7 offset:5632
  ds_read_b64_tr_b16 a[38:39], v7 offset:5808
  ds_read_b64_tr_b16 a[40:41], v7 offset:16912
  ds_read_b64_tr_b16 a[42:43], v7 offset:17088
  ds_read_b64_tr_b16 a[44:45], v8 offset:5632
  ds_read_b64_tr_b16 a[46:47], v8 offset:5808
  s_add_u32 s18, s8, 4
  s_and_b32 s18, s18, 7
  s_mul_i32 s18, s18, 176128
  s_add_u32 s18, s18, s16
  s_add_u32 m0, s17, 0
  s_nop 0
  buffer_load_dwordx4 v64, s[12:15], s18 offen offset:0 lds
  buffer_load_dwordx4 v65, s[12:15], s18 offen offset:1024 lds
  buffer_load_dwordx4 v66, s[12:15], s18 offen offset:2048 lds
  buffer_load_dwordx4 v67, s[12:15], s18 offen offset:3072 lds
  s_add_u32 m0, s17, 4096
  s_nop 0
  buffer_load_dwordx4 v68, s[12:15], s18 offen offset:0 lds
  buffer_load_dwordx4 v69, s[12:15], s18 offen offset:1024 lds
  buffer_load_dwordx4 v70, s[12:15], s18 offen offset:2048 lds
  buffer_load_dwordx4 v71, s[12:15], s18 offen offset:3072 lds
  s_add_u32 m0, s17, 8192
  s_nop 0
  buffer_load_dwordx4 v72, s[12:15], s18 offen offset:0 lds
  buffer_load_dwordx4 v73, s[12:15], s18 offen offset:1024 lds
  buffer_load_dwordx4 v74, s[12:15], s18 offen offset:2048 lds
  s_waitcnt lgkmcnt(0)
  v_mfma_f32_16x16x32_bf16 v[76:79], a[0:3], v[116:119], 0
  v_mfma_f32_16x16x32_bf16 v[80:83], a[4:7], v[116:119], 0
  v_mfma_f32_16x16x32_bf16 v[84:87], a[8:11], v[116:119], 0
  v_mfma_f32_16x16x32_bf16 v[76:79], a[12:15], v[116:119], v[76:79]
  v_mfma_f32_16x16x32_bf16 v[80:83], a[16:19], v[116:119], v[80:83]
  v_mfma_f32_16x16x32_bf16 v[84:87], a[20:23], v[116:119], v[84:87]
  v_mfma_f32_16x16x32_bf16 v[76:79], a[24:27], v[116:119], v[76:79]
  v_mfma_f32_16x16x32_bf16 v[80:83], a[28:31], v[116:119], v[80:83]
  v_mfma_f32_16x16x32_bf16 v[84:87], a[32:35], v[116:119], v[84:87]
  v_mfma_f32_16x16x32_bf16 v[76:79], a[36:39], v[116:119], v[76:79]
  v_mfma_f32_16x16x32_bf16 v[80:83], a[40:43], v[116:119], v[80:83]
  v_mfma_f32_16x16x32_bf16 v[84:87], a[44:47], v[116:119], v[84:87]
  s_waitcnt vmcnt(11)
  ds_write_b16 v120, v143 offset:45120
  s_waitcnt lgkmcnt(0)
  s_barrier
  v_add_u32 v5, 118720, v3
  v_add_u32 v6, 118720, v4
  ds_read_b64_tr_b16 a[48:49], v5 offset:0
  ds_read_b64_tr_b16 a[50:51], v5 offset:176
  ds_read_b64_tr_b16 a[52:53], v5 offset:11280
  ds_read_b64_tr_b16 a[54:55], v5 offset:11456
  ds_read_b64_tr_b16 a[56:57], v6 offset:0
  ds_read_b64_tr_b16 a[58:59], v6 offset:176
  ds_read_b64_tr_b16 a[60:61], v5 offset:5632
  ds_read_b64_tr_b16 a[62:63], v5 offset:5808
  ds_read_b64_tr_b16 a[64:65], v5 offset:16912
  ds_read_b64_tr_b16 a[66:67], v5 offset:17088
  ds_read_b64_tr_b16 a[68:69], v6 offset:5632
  ds_read_b64_tr_b16 a[70:71], v6 offset:5808
  v_add_u32 v7, 141280, v3
  v_add_u32 v8, 141280, v4
  ds_read_b64_tr_b16 a[72:73], v7 offset:0
  ds_read_b64_tr_b16 a[74:75], v7 offset:176
  ds_read_b64_tr_b16 a[76:77], v7 offset:11280
  ds_read_b64_tr_b16 a[78:79], v7 offset:11456
  ds_read_b64_tr_b16 a[80:81], v8 offset:0
  ds_read_b64_tr_b16 a[82:83], v8 offset:176
  ds_read_b64_tr_b16 a[84:85], v7 offset:5632
  ds_read_b64_tr_b16 a[86:87], v7 offset:5808
  ds_read_b64_tr_b16 a[88:89], v7 offset:16912
  ds_read_b64_tr_b16 a[90:91], v7 offset:17088
  ds_read_b64_tr_b16 a[92:93], v8 offset:5632
  ds_read_b64_tr_b16 a[94:95], v8 offset:5808
  s_add_u32 s18, s8, 6
  s_and_b32 s18, s18, 7
  s_mul_i32 s18, s18, 176128
  s_add_u32 s18, s18, s16
  s_add_u32 m0, s17, 73600
  s_nop 0
  buffer_load_dwordx4 v64, s[12:15], s18 offen offset:0 lds
  buffer_load_dwordx4 v65, s[12:15], s18 offen offset:1024 lds
  buffer_load_dwordx4 v66, s[12:15], s18 offen offset:2048 lds
  buffer_load_dwordx4 v67, s[12:15], s18 offen offset:3072 lds
  s_add_u32 m0, s17, 77696
  s_nop 0
  buffer_load_dwordx4 v68, s[12:15], s18 offen offset:0 lds
  buffer_load_dwordx4 v69, s[12:15], s18 offen offset:1024 lds
  buffer_load_dwordx4 v70, s[12:15], s18 offen offset:2048 lds
  buffer_load_dwordx4 v71, s[12:15], s18 offen offset:3072 lds
  s_add_u32 m0, s17, 81792
  s_nop 0
  buffer_load_dwordx4 v72, s[12:15], s18 offen offset:0 lds
  buffer_load_dwordx4 v73, s[12:15], s18 offen offset:1024 lds
  buffer_load_dwordx4 v74, s[12:15], s18 offen offset:2048 lds
  s_mov_b32 s6, 0
  s_cmp_lg_u32 s56, 0
  s_cbranch_scc1 L_nofb2
  buffer_load_dwordx4 v[32:35], v1, s[44:47], s64 offen offset:0 sc1
  buffer_load_dwordx4 v[36:39], v1, s[44:47], s64 offen offset:1024 sc1
  s_waitcnt vmcnt(13)
  s_branch L_fb3
L_nofb2:
  s_waitcnt vmcnt(11)
L_fb3:
  ds_write_b16 v122, v143 offset:0
  s_waitcnt lgkmcnt(0)
  s_barrier
  v_add_u32 v5, 0, v3
  v_add_u32 v6, 0, v4
  ds_read_b64_tr_b16 a[96:97], v5 offset:0
  ds_read_b64_tr_b16 a[98:99], v5 offset:176
  ds_read_b64_tr_b16 a[100:101], v5 offset:11280
  ds_read_b64_tr_b16 a[102:103], v5 offset:11456
  ds_read_b64_tr_b16 a[104:105], v6 offset:0
  ds_read_b64_tr_b16 a[106:107], v6 offset:176
  ds_read_b64_tr_b16 a[108:109], v5 offset:5632
  ds_read_b64_tr_b16 a[110:111], v5 offset:5808
  ds_read_b64_tr_b16 a[112:113], v5 offset:16912
  ds_read_b64_tr_b16 a[114:115], v5 offset:17088
  ds_read_b64_tr_b16 a[116:117], v6 offset:5632
  ds_read_b64_tr_b16 a[118:119], v6 offset:5808
  v_add_u32 v7, 22560, v3
  v_add_u32 v8, 22560, v4
  ds_read_b64_tr_b16 a[120:121], v7 offset:0
  ds_read_b64_tr_b16 a[122:123], v7 offset:176
  ds_read_b64_tr_b16 a[124:125], v7 offset:11280
  ds_read_b64_tr_b16 a[126:127], v7 offset:11456
  ds_read_b64_tr_b16 a[128:129], v8 offset:0
  ds_read_b64_tr_b16 a[130:131], v8 offset:176
  ds_read_b64_tr_b16 a[132:133], v7 offset:5632
  ds_read_b64_tr_b16 a[134:135], v7 offset:5808
  ds_read_b64_tr_b16 a[136:137], v7 offset:16912
  ds_read_b64_tr_b16 a[138:139], v7 offset:17088
  ds_read_b64_tr_b16 a[140:141], v8 offset:5632
  ds_read_b64_tr_b16 a[142:143], v8 offset:5808
  s_branch L_warm3
  s_nop 0
L_warm3r:
  v_mfma_f32_16x16x32_bf16 v[76:79], a[48:51], v[116:119], v[76:79]
  v_mfma_f32_16x16x32_bf16 v[80:83], a[52:55], v[116:119], v[80:83]
  v_mfma_f32_16x16x32_bf16 v[84:87], a[56:59], v[116:119], v[84:87]
  v_mfma_f32_16x16x32_bf16 v[76:79], a[60:63], v[116:119], v[76:79]
  v_mfma_f32_16x16x32_bf16 v[80:83], a[64:67], v[116:119], v[80:83]
  v_mfma_f32_16x16x32_bf16 v[84:87], a[68:71], v[116:119], v[84:87]
  v_mfma_f32_16x16x32_bf16 v[76:79], a[72:75], v[116:119], v[76:79]
  v_mfma_f32_16x16x32_bf16 v[80:83], a[76:79], v[116:119], v[80:83]
  v_mfma_f32_16x16x32_bf16 v[84:87], a[80:83], v[116:119], v[84:87]
  v_mfma_f32_16x16x32_bf16 v[76:79], a[84:87], v[116:119], v[76:79]
  v_mfma_f32_16x16x32_bf16 v[80:83], a[88:91], v[116:119], v[80:83]
  v_mfma_f32_16x16x32_bf16 v[84:87], a[92:95], v[116:119], v[84:87]
  s_waitcnt lgkmcnt(0)
  v_mfma_f32_16x16x32_bf16 v[76:79], a[96:99], v[116:119], v[76:79]
  v_mfma_f32_16x16x32_bf16 v[80:83], a[100:103], v[116:119], v[80:83]
  v_mfma_f32_16x16x32_bf16 v[84:87], a[104:107], v[116:119], v[84:87]
  v_mfma_f32_16x16x32_bf16 v[76:79], a[108:111], v[116:119], v[76:79]
  v_mfma_f32_16x16x32_bf16 v[80:83], a[112:115], v[116:119], v[80:83]
  v_mfma_f32_16x16x32_bf16 v[84:87], a[116:119], v[116:119], v[84:87]
  v_mfma_f32_16x16x32_bf16 v[76:79], a[120:123], v[116:119], v[76:79]
  v_mfma_f32_16x16x32_bf16 v[80:83], a[124:127], v[116:119], v[80:83]
  v_mfma_f32_16x16x32_bf16 v[84:87], a[128:131], v[116:119], v[84:87]
  v_mfma_f32_16x16x32_bf16 v[76:79], a[132:135], v[116:119], v[76:79]
  v_mfma_f32_16x16x32_bf16 v[80:83], a[136:139], v[116:119], v[80:83]
  v_mfma_f32_16x16x32_bf16 v[84:87], a[140:143], v[116:119], v[84:87]
  s_waitcnt vmcnt(0)
  s_cmp_lg_u32 s56, 0
  s_cbranch_scc1 L_bar6
L_fbchk:
  v_cmp_ne_u64 vcc, s[4:5], v[32:33]
  v_cmp_ne_u64 s[60:61], s[4:5], v[34:35]
  v_cmp_ne_u64 s[62:63], s[4:5], v[36:37]
  v_cmp_ne_u64 s[66:67], s[4:5], v[38:39]
  s_or_b64 vcc, vcc, s[60:61]
  s_or_b64 s[62:63], s[62:63], s[66:67]
  s_or_b64 vcc, vcc, s[62:63]
  s_cbranch_vccz L_bar6
  s_sleep 16
  buffer_load_dwordx4 v[32:35], v1, s[44:47], s64 offen offset:0 sc1
  buffer_load_dwordx4 v[36:39], v1, s[44:47], s64 offen offset:1024 sc1
  s_waitcnt vmcnt(0)
  s_add_u32 s6, s6, 1
  s_cmp_lt_u32 s6, 1048576
  s_cbranch_scc1 L_fbchk
L_bar6:
  ds_write_b16 v120, v143 offset:0
  s_waitcnt lgkmcnt(0)
  s_barrier
  s_add_u32 s77, s76, 0
  s_and_b32 s77, s77, 0xffff
  s_add_u32 m0, s24, 0
  s_nop 0
  buffer_load_dwordx4 v126, s[44:47], s77 offen sc1 lds
  s_add_u32 s77, s76, 4096
  s_and_b32 s77, s77, 0xffff
  s_add_u32 m0, s24, 4096
  s_nop 0
  buffer_load_dwordx4 v126, s[44:47], s77 offen sc1 lds
  s_add_u32 s77, s76, 8192
  s_and_b32 s77, s77, 0xffff
  s_add_u32 m0, s24, 8192
  s_nop 0
  buffer_load_dwordx4 v126, s[44:47], s77 offen sc1 lds
  s_add_u32 s77, s76, 12288
  s_and_b32 s77, s77, 0xffff
  s_add_u32 m0, s24, 12288
  s_nop 0
  buffer_load_dwordx4 v126, s[44:47], s77 offen sc1 lds
  s_add_u32 s77, s76, 16384
  s_and_b32 s77, s77, 0xffff
  s_add_u32 m0, s24, 16384
  s_nop 0
  buffer_load_dwordx4 v126, s[44:47], s77 offen sc1 lds
  s_add_u32 s77, s76, 20480
  s_and_b32 s77, s77, 0xffff
  s_add_u32 m0, s24, 20480
  s_nop 0
  buffer_load_dwordx4 v126, s[44:47], s77 offen sc1 lds
  s_add_u32 s77, s76, 24576
  s_and_b32 s77, s77, 0xffff
  s_add_u32 m0, s24, 24576
  s_nop 0
  buffer_load_dwordx4 v126, s[44:47], s77 offen sc1 lds
  s_add_u32 s77, s76, 28672
  s_and_b32 s77, s77, 0xffff
  s_add_u32 m0, s24, 28672
  s_nop 0
  buffer_load_dwordx4 v126, s[44:47], s77 offen sc1 lds
  s_add_u32 s77, s76, 32768
  s_and_b32 s77, s77, 0xffff
  s_add_u32 m0, s24, 32768
  s_nop 0
  buffer_load_dwordx4 v126, s[44:47], s77 offen sc1 lds
  s_add_u32 s77, s76, 36864
  s_and_b32 s77, s77, 0xffff
  s_add_u32 m0, s24, 36864
  s_nop 0
  buffer_load_dwordx4 v126, s[44:47], s77 offen sc1 lds
  s_add_u32 s77, s76, 40960
  s_and_b32 s77, s77, 0xffff
  s_add_u32 m0, s24, 40960
  s_nop 0
  buffer_load_dwordx4 v126, s[44:47], s77 offen sc1 lds
  s_add_u32 s77, s76, 45056
  s_and_b32 s77, s77, 0xffff
  s_add_u32 m0, s24, 45056
  s_nop 0
  buffer_load_dwordx4 v126, s[44:47], s77 offen sc1 lds
  v_add_u32 v5, 73600, v3
  v_add_u32 v6, 73600, v4
  ds_read_b64_tr_b16 a[144:145], v5 offset:0
  ds_read_b64_tr_b16 a[146:147], v5 offset:176
  ds_read_b64_tr_b16 a[148:149], v5 offset:11280
  ds_read_b64_tr_b16 a[150:151], v5 offset:11456
  ds_read_b64_tr_b16 a[152:153], v6 offset:0
  ds_read_b64_tr_b16 a[154:155], v6 offset:176
  ds_read_b64_tr_b16 a[156:157], v5 offset:5632
  ds_read_b64_tr_b16 a[158:159], v5 offset:5808
  ds_read_b64_tr_b16 a[160:161], v5 offset:16912
  ds_read_b64_tr_b16 a[162:163], v5 offset:17088
  ds_read_b64_tr_b16 a[164:165], v6 offset:5632
  ds_read_b64_tr_b16 a[166:167], v6 offset:5808
  v_add_u32 v7, 96160, v3
  v_add_u32 v8, 96160, v4
  ds_read_b64_tr_b16 a[168:169], v7 offset:0
  ds_read_b64_tr_b16 a[170:171], v7 offset:176
  ds_read_b64_tr_b16 a[172:173], v7 offset:11280
  ds_read_b64_tr_b16 a[174:175], v7 offset:11456
  ds_read_b64_tr_b16 a[176:177], v8 offset:0
  ds_read_b64_tr_b16 a[178:179], v8 offset:176
  ds_read_b64_tr_b16 a[180:181], v7 offset:5632
  ds_read_b64_tr_b16 a[182:183], v7 offset:5808
  ds_read_b64_tr_b16 a[184:185], v7 offset:16912
  ds_read_b64_tr_b16 a[186:187], v7 offset:17088
  ds_read_b64_tr_b16 a[188:189], v8 offset:5632
  ds_read_b64_tr_b16 a[190:191], v8 offset:5808
  s_waitcnt lgkmcnt(0)
  v_mfma_f32_16x16x32_bf16 v[76:79], a[144:147], v[116:119], v[76:79]
  v_mfma_f32_16x16x32_bf16 v[80:83], a[148:151], v[116:119], v[80:83]
  v_mfma_f32_16x16x32_bf16 v[84:87], a[152:155], v[116:119], v[84:87]
  v_mfma_f32_16x16x32_bf16 v[76:79], a[156:159], v[116:119], v[76:79]
  v_mfma_f32_16x16x32_bf16 v[80:83], a[160:163], v[116:119], v[80:83]
  v_mfma_f32_16x16x32_bf16 v[84:87], a[164:167], v[116:119], v[84:87]
  v_mfma_f32_16x16x32_bf16 v[76:79], a[168:171], v[116:119], v[76:79]
  v_mfma_f32_16x16x32_bf16 v[80:83], a[172:175], v[116:119], v[80:83]
  v_mfma_f32_16x16x32_bf16 v[84:87], a[176:179], v[116:119], v[84:87]
  v_mfma_f32_16x16x32_bf16 v[76:79], a[180:183], v[116:119], v[76:79]
  v_mfma_f32_16x16x32_bf16 v[80:83], a[184:187], v[116:119], v[80:83]
  v_mfma_f32_16x16x32_bf16 v[84:87], a[188:191], v[116:119], v[84:87]
  s_waitcnt vmcnt(8)
  s_barrier
  s_cmp_eq_u32 s56, 3
  s_cbranch_scc1 L_p2w3
  v_xor_b32 v10, 0, v9
  v_xor_b32 v11, 32, v9
  v_xor_b32 v139, 64, v9
  v_xor_b32 v140, 96, v9
  ds_read_b64_tr_b16 v[88:89], v10 offset:0
  ds_read_b64_tr_b16 v[90:91], v10 offset:1024
  ds_read_b64_tr_b16 v[92:93], v11 offset:0
  ds_read_b64_tr_b16 v[94:95], v11 offset:1024
  ds_read_b64_tr_b16 v[96:97], v10 offset:4096
  ds_read_b64_tr_b16 v[98:99], v10 offset:5120
  ds_read_b64_tr_b16 v[100:101], v11 offset:4096
  ds_read_b64_tr_b16 v[102:103], v11 offset:5120
  s_waitcnt lgkmcnt(6)
  v_mfma_f32_16x16x32_bf16 v[144:147], a[0:3], v[88:91], 0
  ds_read_b64_tr_b16 v[104:105], v10 offset:8192
  ds_read_b64_tr_b16 v[106:107], v10 offset:9216
  v_mfma_f32_16x16x32_bf16 v[148:151], a[4:7], v[88:91], 0
  s_add_u32 s77, s76, 49152
  s_and_b32 s77, s77, 0xffff
  s_add_u32 m0, s24, 49152
  s_nop 0
  buffer_load_dwordx4 v126, s[44:47], s77 offen sc1 lds
  v_bfe_u32 v40, v0, 2, 1
  v_mfma_f32_16x16x32_bf16 v[152:155], a[8:11], v[88:91], 0
  s_waitcnt lgkmcnt(6)
  v_lshlrev_b32 v40, 3, v40
  v_bfe_u32 v41, v0, 5, 1
  v_mfma_f32_16x16x32_bf16 v[156:159], a[0:3], v[92:95], 0
  ds_read_b64_tr_b16 v[88:89], v11 offset:8192
  ds_read_b64_tr_b16 v[90:91], v11 offset:9216
  v_mfma_f32_16x16x32_bf16 v[160:163], a[4:7], v[92:95], 0
  s_add_u32 s77, s76, 53248
  s_and_b32 s77, s77, 0xffff
  s_add_u32 m0, s24, 53248
  s_nop 0
  buffer_load_dwordx4 v126, s[44:47], s77 offen sc1 lds
  v_lshl_add_u32 v40, v41, 1, v40
  v_mfma_f32_16x16x32_bf16 v[164:167], a[8:11], v[92:95], 0
  s_waitcnt lgkmcnt(6)
  v_bfe_u32 v42, v0, 3, 1
  v_add_u32 v40, v40, v42
  v_mfma_f32_16x16x32_bf16 v[144:147], a[12:15], v[96:99], v[144:147]
  ds_read_b64_tr_b16 v[92:93], v10 offset:12288
  ds_read_b64_tr_b16 v[94:95], v10 offset:13312
  v_mfma_f32_16x16x32_bf16 v[148:151], a[16:19], v[96:99], v[148:151]
  s_add_u32 s77, s76, 57344
  s_and_b32 s77, s77, 0xffff
  s_add_u32 m0, s24, 57344
  s_nop 0
  buffer_load_dwordx4 v126, s[44:47], s77 offen sc1 lds
  v_lshlrev_b32 v40, 7, v40
  v_mfma_f32_16x16x32_bf16 v[152:155], a[20:23], v[96:99], v[152:155]
  s_waitcnt lgkmcnt(6)
  v_bfe_u32 v42, v0, 4, 1
  v_mfma_f32_16x16x32_bf16 v[156:159], a[12:15], v[100:103], v[156:159]
  ds_read_b64_tr_b16 v[96:97], v11 offset:12288
  ds_read_b64_tr_b16 v[98:99], v11 offset:13312
  s_and_b32 s60, s56, 2
  v_mfma_f32_16x16x32_bf16 v[160:163], a[16:19], v[100:103], v[160:163]
  s_add_u32 s77, s76, 61440
  s_and_b32 s77, s77, 0xffff
  s_add_u32 m0, s24, 61440
  s_nop 0
  buffer_load_dwordx4 v126, s[44:47], s77 offen sc1 lds
  v_add_u32 v42, s60, v42
  v_mfma_f32_16x16x32_bf16 v[164:167], a[20:23], v[100:103], v[164:167]
  s_waitcnt lgkmcnt(6)
  v_xor_b32 v42, v42, v41
  v_lshl_add_u32 v40, v42, 5, v40
  v_mfma_f32_16x16x32_bf16 v[144:147], a[24:27], v[104:107], v[144:147]
  s_waitcnt vmcnt(8)
  s_barrier
  ds_read_b64_tr_b16 v[100:101], v10 offset:16384
  ds_read_b64_tr_b16 v[102:103], v10 offset:17408
  v_mfma_f32_16x16x32_bf16 v[148:151], a[28:31], v[104:107], v[148:151]
  v_and_b32 v42, 3, v0
  v_lshl_add_u32 v40, v42, 3, v40
  v_mfma_f32_16x16x32_bf16 v[152:155], a[32:35], v[104:107], v[152:155]
  s_and_b32 s60, s56, 1
  s_lshl_b32 s60, s60, 12
  s_lshl_b32 s61, s59, 13
  s_add_u32 s60, s60, s61
  s_sub_u32 s60, s60, s76
  s_and_b32 s60, s60, 0xffff
  s_and_b32 s61, s61, 0x10000
  s_add_u32 s60, s60, s61
  v_add_u32 v136, s60, v40
  v_xor_b32 v137, 64, v136
  s_waitcnt lgkmcnt(6)
  v_mfma_f32_16x16x32_bf16 v[156:159], a[24:27], v[88:91], v[156:159]
  ds_read_b64_tr_b16 v[104:105], v11 offset:16384
  ds_read_b64_tr_b16 v[106:107], v11 offset:17408
  v_mfma_f32_16x16x32_bf16 v[160:163], a[28:31], v[88:91], v[160:163]
  v_mov_b32 v143, s4
  v_permlane16_swap_b32 v84, v86
  v_mfma_f32_16x16x32_bf16 v[164:167], a[32:35], v[88:91], v[164:167]
  s_waitcnt lgkmcnt(6)
  s_add_u32 s77, s76, 0
  s_and_b32 s77, s77, 0xffff
  v_permlane16_swap_b32 v85, v87
  v_mfma_f32_16x16x32_bf16 v[144:147], a[36:39], v[92:95], v[144:147]
  s_add_u32 m0, s24, 65536
  ds_read_b64_tr_b16 v[88:89], v10 offset:20480
  ds_read_b64_tr_b16 v[90:91], v10 offset:21504
  v_mfma_f32_16x16x32_bf16 v[148:151], a[40:43], v[92:95], v[148:151]
  buffer_load_dwordx4 v43, s[44:47], s77 offen sc1 lds
  v_mfma_f32_16x16x32_bf16 v[152:155], a[44:47], v[92:95], v[152:155]
  s_waitcnt lgkmcnt(6)
  s_add_u32 s77, s76, 4096
  s_and_b32 s77, s77, 0xffff
  v_mfma_f32_16x16x32_bf16 v[156:159], a[36:39], v[96:99], v[156:159]
  s_add_u32 m0, s24, 69632
  ds_read_b64_tr_b16 v[92:93], v11 offset:20480
  ds_read_b64_tr_b16 v[94:95], v11 offset:21504
  v_mfma_f32_16x16x32_bf16 v[160:163], a[40:43], v[96:99], v[160:163]
  buffer_load_dwordx4 v43, s[44:47], s77 offen sc1 lds
  v_mfma_f32_16x16x32_bf16 v[164:167], a[44:47], v[96:99], v[164:167]
  s_waitcnt lgkmcnt(6)
  s_add_u32 s77, s76, 8192
  s_and_b32 s77, s77, 0xffff
  v_mfma_f32_16x16x32_bf16 v[144:147], a[48:51], v[100:103], v[144:147]
  s_add_u32 m0, s24, 73728
  ds_read_b64_tr_b16 v[96:97], v10 offset:24576
  ds_read_b64_tr_b16 v[98:99], v10 offset:25600
  v_mfma_f32_16x16x32_bf16 v[148:151], a[52:55], v[100:103], v[148:151]
  buffer_load_dwordx4 v43, s[44:47], s77 offen sc1 lds
  v_mfma_f32_16x16x32_bf16 v[152:155], a[56:59], v[100:103], v[152:155]
  s_waitcnt lgkmcnt(6)
  s_add_u32 s77, s76, 12288
  s_and_b32 s77, s77, 0xffff
  v_mfma_f32_16x16x32_bf16 v[156:159], a[48:51], v[104:107], v[156:159]
  s_add_u32 m0, s24, 77824
  ds_read_b64_tr_b16 v[100:101], v11 offset:24576
  ds_read_b64_tr_b16 v[102:103], v11 offset:25600
  v_mfma_f32_16x16x32_bf16 v[160:163], a[52:55], v[104:107], v[160:163]
  buffer_load_dwordx4 v43, s[44:47], s77 offen sc1 lds
  v_mfma_f32_16x16x32_bf16 v[164:167], a[56:59], v[104:107], v[164:167]
  s_waitcnt lgkmcnt(6)
  s_add_u32 s77, s76, 16384
  s_and_b32 s77, s77, 0xffff
  v_mfma_f32_16x16x32_bf16 v[144:147], a[60:63], v[88:91], v[144:147]
  s_add_u32 m0, s24, 81920
  ds_read_b64_tr_b16 v[104:105], v10 offset:28672
  ds_read_b64_tr_b16 v[106:107], v10 offset:29696
  v_mfma_f32_16x16x32_bf16 v[148:151], a[64:67], v[88:91], v[148:151]
  buffer_load_dwordx4 v43, s[44:47], s77 offen sc1 lds
  v_mfma_f32_16x16x32_bf16 v[152:155], a[68:71], v[88:91], v[152:155]
  s_waitcnt lgkmcnt(6)
  s_add_u32 s77, s76, 20480
  s_and_b32 s77, s77, 0xffff
  v_mfma_f32_16x16x32_bf16 v[156:159], a[60:63], v[92:95], v[156:159]
  s_add_u32 m0, s24, 86016
  ds_read_b64_tr_b16 v[88:89], v11 offset:28672
  ds_read_b64_tr_b16 v[90:91], v11 offset:29696
  v_mfma_f32_16x16x32_bf16 v[160:163], a[64:67], v[92:95], v[160:163]
  buffer_load_dwordx4 v43, s[44:47], s77 offen sc1 lds
  v_mfma_f32_16x16x32_bf16 v[164:167], a[68:71], v[92:95], v[164:167]
  s_waitcnt lgkmcnt(6)
  s_add_u32 s77, s76, 24576
  s_and_b32 s77, s77, 0xffff
  v_mfma_f32_16x16x32_bf16 v[144:147], a[72:75], v[96:99], v[144:147]
  s_waitcnt vmcnt(10)
  s_barrier
  s_add_u32 m0, s24, 90112
  ds_read_b64_tr_b16 v[92:93], v10 offset:32768
  ds_read_b64_tr_b16 v[94:95], v10 offset:33792
  v_mfma_f32_16x16x32_bf16 v[148:151], a[76:79], v[96:99], v[148:151]
  buffer_load_dwordx4 v43, s[44:47], s77 offen sc1 lds
  v_mfma_f32_16x16x32_bf16 v[152:155], a[80:83], v[96:99], v[152:155]
  s_waitcnt lgkmcnt(6)
  s_add_u32 s77, s76, 28672
  s_and_b32 s77, s77, 0xffff
  v_mfma_f32_16x16x32_bf16 v[156:159], a[72:75], v[100:103], v[156:159]
  s_add_u32 m0, s24, 94208
  ds_read_b64_tr_b16 v[96:97], v11 offset:32768
  ds_read_b64_tr_b16 v[98:99], v11 offset:33792
  v_mfma_f32_16x16x32_bf16 v[160:163], a[76:79], v[100:103], v[160:163]
  buffer_load_dwordx4 v43, s[44:47], s77 offen sc1 lds
  v_mfma_f32_16x16x32_bf16 v[164:167], a[80:83], v[100:103], v[164:167]
  s_waitcnt lgkmcnt(6)
  s_add_u32 s77, s76, 32768
  s_and_b32 s77, s77, 0xffff
  v_mfma_f32_16x16x32_bf16 v[144:147], a[84:87], v[104:107], v[144:147]
  s_add_u32 m0, s24, 98304
  ds_read_b64_tr_b16 v[100:101], v10 offset:36864
  ds_read_b64_tr_b16 v[102:103], v10 offset:37888
  v_mfma_f32_16x16x32_bf16 v[148:151], a[88:91], v[104:107], v[148:151]
  buffer_load_dwordx4 v43, s[44:47], s77 offen sc1 lds
  v_mfma_f32_16x16x32_bf16 v[152:155], a[92:95], v[104:107], v[152:155]
  s_waitcnt lgkmcnt(6)
  s_add_u32 s77, s76, 36864
  s_and_b32 s77, s77, 0xffff
  v_mfma_f32_16x16x32_bf16 v[156:159], a[84:87], v[88:91], v[156:159]
  s_add_u32 m0, s24, 102400
  ds_read_b64_tr_b16 v[104:105], v11 offset:36864
  ds_read_b64_tr_b16 v[106:107], v11 offset:37888
  v_mfma_f32_16x16x32_bf16 v[160:163], a[88:91], v[88:91], v[160:163]
  buffer_load_dwordx4 v43, s[44:47], s77 offen sc1 lds
  v_mfma_f32_16x16x32_bf16 v[164:167], a[92:95], v[88:91], v[164:167]
  s_waitcnt lgkmcnt(6)
  s_add_u32 s77, s76, 40960
  s_and_b32 s77, s77, 0xffff
  v_mfma_f32_16x16x32_bf16 v[144:147], a[96:99], v[92:95], v[144:147]
  s_add_u32 m0, s24, 106496
  ds_read_b64_tr_b16 v[88:89], v10 offset:40960
  ds_read_b64_tr_b16 v[90:91], v10 offset:41984
  v_mfma_f32_16x16x32_bf16 v[148:151], a[100:103], v[92:95], v[148:151]
  buffer_load_dwordx4 v43, s[44:47], s77 offen sc1 lds
  v_mfma_f32_16x16x32_bf16 v[152:155], a[104:107], v[92:95], v[152:155]
  s_waitcnt lgkmcnt(6)
  s_add_u32 s77, s76, 45056
  s_and_b32 s77, s77, 0xffff
  v_mfma_f32_16x16x32_bf16 v[156:159], a[96:99], v[96:99], v[156:159]
  s_add_u32 m0, s24, 110592
  ds_read_b64_tr_b16 v[92:93], v11 offset:40960
  ds_read_b64_tr_b16 v[94:95], v11 offset:41984
  v_mfma_f32_16x16x32_bf16 v[160:163], a[100:103], v[96:99], v[160:163]
  buffer_load_dwordx4 v43, s[44:47], s77 offen sc1 lds
  v_mfma_f32_16x16x32_bf16 v[164:167], a[104:107], v[96:99], v[164:167]
  s_waitcnt lgkmcnt(6)
  s_add_u32 s77, s76, 49152
  s_and_b32 s77, s77, 0xffff
  v_mfma_f32_16x16x32_bf16 v[144:147], a[108:111], v[100:103], v[144:147]
  s_add_u32 m0, s24, 114688
  ds_read_b64_tr_b16 v[96:97], v10 offset:45056
  ds_read_b64_tr_b16 v[98:99], v10 offset:46080
  v_mfma_f32_16x16x32_bf16 v[148:151], a[112:115], v[100:103], v[148:151]
  buffer_load_dwordx4 v43, s[44:47], s77 offen sc1 lds
  v_mfma_f32_16x16x32_bf16 v[152:155], a[116:119], v[100:103], v[152:155]
  s_waitcnt lgkmcnt(6)
  s_add_u32 s77, s76, 53248
  s_and_b32 s77, s77, 0xffff
  v_mfma_f32_16x16x32_bf16 v[156:159], a[108:111], v[104:107], v[156:159]
  s_add_u32 m0, s24, 118784
  ds_read_b64_tr_b16 v[100:101], v11 offset:45056
  ds_read_b64_tr_b16 v[102:103], v11 offset:46080
  v_mfma_f32_16x16x32_bf16 v[160:163], a[112:115], v[104:107], v[160:163]
  buffer_load_dwordx4 v43, s[44:47], s77 offen sc1 lds
  v_mfma_f32_16x16x32_bf16 v[164:167], a[116:119], v[104:107], v[164:167]
  s_waitcnt lgkmcnt(6)
  s_add_u32 s77, s76, 57344
  s_and_b32 s77, s77, 0xffff
  v_mfma_f32_16x16x32_bf16 v[144:147], a[120:123], v[88:91], v[144:147]
  s_waitcnt vmcnt(14)
  s_barrier
  s_add_u32 m0, s24, 122880
  ds_read_b64_tr_b16 v[104:105], v10 offset:49152
  ds_read_b64_tr_b16 v[106:107], v10 offset:50176
  v_mfma_f32_16x16x32_bf16 v[148:151], a[124:127], v[88:91], v[148:151]
  buffer_load_dwordx4 v43, s[44:47], s77 offen sc1 lds
  v_mfma_f32_16x16x32_bf16 v[152:155], a[128:131], v[88:91], v[152:155]
  s_waitcnt lgkmcnt(6)
  s_add_u32 s77, s76, 61440
  s_and_b32 s77, s77, 0xffff
  v_mfma_f32_16x16x32_bf16 v[156:159], a[120:123], v[92:95], v[156:159]
  s_add_u32 m0, s24, 126976
  ds_read_b64_tr_b16 v[88:89], v11 offset:49152
  ds_read_b64_tr_b16 v[90:91], v11 offset:50176
  v_mfma_f32_16x16x32_bf16 v[160:163], a[124:127], v[92:95], v[160:163]
  buffer_load_dwordx4 v43, s[44:47], s77 offen sc1 lds
  v_mfma_f32_16x16x32_bf16 v[164:167], a[128:131], v[92:95], v[164:167]
  s_waitcnt lgkmcnt(6)
  v_mfma_f32_16x16x32_bf16 v[144:147], a[132:135], v[96:99], v[144:147]
  ds_read_b64_tr_b16 v[92:93], v10 offset:53248
  ds_read_b64_tr_b16 v[94:95], v10 offset:54272
  v_mfma_f32_16x16x32_bf16 v[148:151], a[136:139], v[96:99], v[148:151]
  s_mov_b32 exec_hi, 0x1fff
  buffer_load_dword a255, v127, s[44:47], 0 offen sc1
  s_mov_b64 exec, -1
  v_mfma_f32_16x16x32_bf16 v[152:155], a[140:143], v[96:99], v[152:155]
  s_waitcnt lgkmcnt(6)
  s_add_u32 m0, s24, 135168
  v_mfma_f32_16x16x32_bf16 v[156:159], a[132:135], v[100:103], v[156:159]
  s_add_u32 s77, s7, 0
  ds_read_b64_tr_b16 v[96:97], v11 offset:53248
  ds_read_b64_tr_b16 v[98:99], v11 offset:54272
  v_mfma_f32_16x16x32_bf16 v[160:163], a[136:139], v[100:103], v[160:163]
  buffer_load_dwordx4 v124, s[36:39], s77 offen  lds
  v_mfma_f32_16x16x32_bf16 v[164:167], a[140:143], v[100:103], v[164:167]
  s_waitcnt lgkmcnt(6)
  v_mfma_f32_16x16x32_bf16 v[144:147], a[144:147], v[104:107], v[144:147]
  ds_read_b64_tr_b16 v[100:101], v10 offset:57344
  ds_read_b64_tr_b16 v[102:103], v10 offset:58368
  v_mfma_f32_16x16x32_bf16 v[148:151], a[148:151], v[104:107], v[148:151]
  v_mfma_f32_16x16x32_bf16 v[152:155], a[152:155], v[104:107], v[152:155]
  s_waitcnt lgkmcnt(6)
  s_add_u32 m0, s24, 139264
  v_mfma_f32_16x16x32_bf16 v[156:159], a[144:147], v[88:91], v[156:159]
  s_add_u32 s77, s7, 16384
  ds_read_b64_tr_b16 v[104:105], v11 offset:57344
  ds_read_b64_tr_b16 v[106:107], v11 offset:58368
  v_mfma_f32_16x16x32_bf16 v[160:163], a[148:151], v[88:91], v[160:163]
  buffer_load_dwordx4 v124, s[36:39], s77 offen  lds
  v_mfma_f32_16x16x32_bf16 v[164:167], a[152:155], v[88:91], v[164:167]
  s_waitcnt lgkmcnt(6)
  v_mfma_f32_16x16x32_bf16 v[144:147], a[156:159], v[92:95], v[144:147]
  ds_read_b64_tr_b16 v[88:89], v10 offset:61440
  ds_read_b64_tr_b16 v[90:91], v10 offset:62464
  v_mfma_f32_16x16x32_bf16 v[148:151], a[160:163], v[92:95], v[148:151]
  v_mfma_f32_16x16x32_bf16 v[152:155], a[164:167], v[92:95], v[152:155]
  s_waitcnt lgkmcnt(6)
  s_add_u32 m0, s24, 143360
  v_mfma_f32_16x16x32_bf16 v[156:159], a[156:159], v[96:99], v[156:159]
  s_add_u32 s77, s7, 32768
  ds_read_b64_tr_b16 v[92:93], v11 offset:61440
  ds_read_b64_tr_b16 v[94:95], v11 offset:62464
  v_mfma_f32_16x16x32_bf16 v[160:163], a[160:163], v[96:99], v[160:163]
  buffer_load_dwordx4 v124, s[36:39], s77 offen  lds
  v_mfma_f32_16x16x32_bf16 v[164:167], a[164:167], v[96:99], v[164:167]
  s_waitcnt lgkmcnt(6)
  v_mfma_f32_16x16x32_bf16 v[144:147], a[168:171], v[100:103], v[144:147]
  ds_read_b64_tr_b16 v[96:97], v139 offset:0
  ds_read_b64_tr_b16 v[98:99], v139 offset:1024
  v_mfma_f32_16x16x32_bf16 v[148:151], a[172:175], v[100:103], v[148:151]
  v_mfma_f32_16x16x32_bf16 v[152:155], a[176:179], v[100:103], v[152:155]
  s_waitcnt lgkmcnt(6)
  s_add_u32 m0, s24, 147456
  v_mfma_f32_16x16x32_bf16 v[156:159], a[168:171], v[104:107], v[156:159]
  s_add_u32 s77, s7, 49152
  ds_read_b64_tr_b16 v[100:101], v139 offset:4096
  ds_read_b64_tr_b16 v[102:103], v139 offset:5120
  v_mfma_f32_16x16x32_bf16 v[160:163], a[172:175], v[104:107], v[160:163]
  buffer_load_dwordx4 v124, s[36:39], s77 offen  lds
  v_mfma_f32_16x16x32_bf16 v[164:167], a[176:179], v[104:107], v[164:167]
  s_waitcnt lgkmcnt(6)
  v_mfma_f32_16x16x32_bf16 v[144:147], a[180:183], v[88:91], v[144:147]
  ds_read_b64_tr_b16 v[104:105], v139 offset:8192
  ds_read_b64_tr_b16 v[106:107], v139 offset:9216
  v_mfma_f32_16x16x32_bf16 v[148:151], a[184:187], v[88:91], v[148:151]
  v_mfma_f32_16x16x32_bf16 v[152:155], a[188:191], v[88:91], v[152:155]
  s_waitcnt lgkmcnt(6)
  s_add_u32 m0, s24, 151552
  v_mfma_f32_16x16x32_bf16 v[156:159], a[180:183], v[92:95], v[156:159]
  s_add_u32 s77, s7, 65536
  ds_read_b64_tr_b16 v[88:89], v139 offset:12288
  ds_read_b64_tr_b16 v[90:91], v139 offset:13312
  v_mfma_f32_16x16x32_bf16 v[160:163], a[184:187], v[92:95], v[160:163]
  buffer_load_dwordx4 v124, s[36:39], s77 offen  lds
  v_mfma_f32_16x16x32_bf16 v[164:167], a[188:191], v[92:95], v[164:167]
  s_waitcnt lgkmcnt(6)
  v_mfma_f32_16x16x32_bf16 v[168:171], a[0:3], v[96:99], 0
  ds_read_b64_tr_b16 v[92:93], v139 offset:16384
  ds_read_b64_tr_b16 v[94:95], v139 offset:17408
  v_mfma_f32_16x16x32_bf16 v[172:175], a[4:7], v[96:99], 0
  v_mfma_f32_16x16x32_bf16 v[176:179], a[8:11], v[96:99], 0
  s_waitcnt lgkmcnt(6)
  s_add_u32 m0, s24, 155648
  v_mfma_f32_16x16x32_bf16 v[168:171], a[12:15], v[100:103], v[168:171]
  s_add_u32 s77, s74, 81920
  ds_read_b64_tr_b16 v[96:97], v139 offset:20480
  ds_read_b64_tr_b16 v[98:99], v139 offset:21504
  v_mfma_f32_16x16x32_bf16 v[172:175], a[16:19], v[100:103], v[172:175]
  buffer_load_dwordx4 v124, s[36:39], s77 offen  lds
  v_mfma_f32_16x16x32_bf16 v[176:179], a[20:23], v[100:103], v[176:179]
  s_waitcnt lgkmcnt(6)
  v_mfma_f32_16x16x32_bf16 v[168:171], a[24:27], v[104:107], v[168:171]
  ds_read_b64_tr_b16 v[100:101], v139 offset:24576
  ds_read_b64_tr_b16 v[102:103], v139 offset:25600
  v_mfma_f32_16x16x32_bf16 v[172:175], a[28:31], v[104:107], v[172:175]
  v_mfma_f32_16x16x32_bf16 v[176:179], a[32:35], v[104:107], v[176:179]
  s_waitcnt lgkmcnt(6)
  s_add_u32 m0, s24, 159744
  v_mfma_f32_16x16x32_bf16 v[168:171], a[36:39], v[88:91], v[168:171]
  s_add_u32 s77, s7, 96256
  ds_read_b64_tr_b16 v[104:105], v139 offset:28672
  ds_read_b64_tr_b16 v[106:107], v139 offset:29696
  v_mfma_f32_16x16x32_bf16 v[172:175], a[40:43], v[88:91], v[172:175]
  buffer_load_dwordx4 v124, s[36:39], s77 offen  lds
  v_mfma_f32_16x16x32_bf16 v[176:179], a[44:47], v[88:91], v[176:179]
  s_waitcnt lgkmcnt(6)
  v_mfma_f32_16x16x32_bf16 v[168:171], a[48:51], v[92:95], v[168:171]
  ds_read_b64_tr_b16 v[88:89], v139 offset:32768
  ds_read_b64_tr_b16 v[90:91], v139 offset:33792
  v_mfma_f32_16x16x32_bf16 v[172:175], a[52:55], v[92:95], v[172:175]
  v_mfma_f32_16x16x32_bf16 v[176:179], a[56:59], v[92:95], v[176:179]
  s_waitcnt lgkmcnt(6)
  v_mfma_f32_16x16x32_bf16 v[168:171], a[60:63], v[96:99], v[168:171]
  ds_read_b64_tr_b16 v[92:93], v139 offset:36864
  ds_read_b64_tr_b16 v[94:95], v139 offset:37888
  v_mfma_f32_16x16x32_bf16 v[172:175], a[64:67], v[96:99], v[172:175]
  v_mfma_f32_16x16x32_bf16 v[176:179], a[68:71], v[96:99], v[176:179]
  s_waitcnt lgkmcnt(6)
  v_mfma_f32_16x16x32_bf16 v[168:171], a[72:75], v[100:103], v[168:171]
  ds_read_b64_tr_b16 v[96:97], v139 offset:40960
  ds_read_b64_tr_b16 v[98:99], v139 offset:41984
  v_mfma_f32_16x16x32_bf16 v[172:175], a[76:79], v[100:103], v[172:175]
  v_mfma_f32_16x16x32_bf16 v[176:179], a[80:83], v[100:103], v[176:179]
  s_waitcnt lgkmcnt(6)
  ds_read_b128 v[108:111], v12 offset:0
  v_mfma_f32_16x16x32_bf16 v[168:171], a[84:87], v[104:107], v[168:171]
  ds_read_b64_tr_b16 v[100:101], v139 offset:45056
  ds_read_b64_tr_b16 v[102:103], v139 offset:46080
  v_mfma_f32_16x16x32_bf16 v[172:175], a[88:91], v[104:107], v[172:175]
  v_mfma_f32_16x16x32_bf16 v[176:179], a[92:95], v[104:107], v[176:179]
  s_waitcnt lgkmcnt(7)
  v_mfma_f32_16x16x32_bf16 v[168:171], a[96:99], v[88:91], v[168:171]
  ds_read_b64_tr_b16 v[104:105], v139 offset:49152
  ds_read_b64_tr_b16 v[106:107], v139 offset:50176
  v_mfma_f32_16x16x32_bf16 v[172:175], a[100:103], v[88:91], v[172:175]
  v_permlane16_swap_b32 v152, v154
  v_permlane16_swap_b32 v153, v155
  v_mfma_f32_16x16x32_bf16 v[176:179], a[104:107], v[88:91], v[176:179]
  s_waitcnt lgkmcnt(4)
  s_add_u32 s21, s4, 1
  v_cmp_ne_u32 vcc, s21, v111
  v_mfma_f32_16x16x32_bf16 v[168:171], a[108:111], v[92:95], v[168:171]
  ds_read_b64_tr_b16 v[88:89], v139 offset:53248
  ds_read_b64_tr_b16 v[90:91], v139 offset:54272
  s_cbranch_vccnz L_rt0
L_bk0:
  v_mfma_f32_16x16x32_bf16 v[172:175], a[112:115], v[92:95], v[172:175]
  v_fmac_f32 v144, v108, v76
  v_fmac_f32 v145, v108, v77
  v_mfma_f32_16x16x32_bf16 v[176:179], a[116:119], v[92:95], v[176:179]
  v_fmac_f32 v146, v108, v78
  v_fmac_f32 v147, v108, v79
  v_mfma_f32_16x16x32_bf16 v[168:171], a[120:123], v[96:99], v[168:171]
  ds_read_b64_tr_b16 v[92:93], v139 offset:57344
  ds_read_b64_tr_b16 v[94:95], v139 offset:58368
  v_mfma_f32_16x16x32_bf16 v[172:175], a[124:127], v[96:99], v[172:175]
  v_fmac_f32 v152, v108, v84
  v_fmac_f32 v153, v108, v85
  v_mfma_f32_16x16x32_bf16 v[176:179], a[128:131], v[96:99], v[176:179]
  s_waitcnt lgkmcnt(6)
  v_mul_f32 v144, v144, v109
  v_mul_f32 v145, v145, v109
  v_mfma_f32_16x16x32_bf16 v[168:171], a[132:135], v[100:103], v[168:171]
  ds_read_b64_tr_b16 v[96:97], v139 offset:61440
  ds_read_b64_tr_b16 v[98:99], v139 offset:62464
  v_mfma_f32_16x16x32_bf16 v[172:175], a[136:139], v[100:103], v[172:175]
  v_mul_f32 v146, v146, v109
  v_mul_f32 v147, v147, v109
  v_mfma_f32_16x16x32_bf16 v[176:179], a[140:143], v[100:103], v[176:179]
  s_waitcnt lgkmcnt(6)
  v_mul_f32 v152, v152, v109
  v_mul_f32 v153, v153, v109
  v_mfma_f32_16x16x32_bf16 v[168:171], a[144:147], v[104:107], v[168:171]
  ds_read_b64_tr_b16 v[100:101], v140 offset:0
  ds_read_b64_tr_b16 v[102:103], v140 offset:1024
  v_mfma_f32_16x16x32_bf16 v[172:175], a[148:151], v[104:107], v[172:175]
  v_exp_f32 v144, v144
  v_mfma_f32_16x16x32_bf16 v[176:179], a[152:155], v[104:107], v[176:179]
  s_waitcnt lgkmcnt(6)
  v_exp_f32 v145, v145
  v_mfma_f32_16x16x32_bf16 v[168:171], a[156:159], v[88:91], v[168:171]
  ds_read_b64_tr_b16 v[104:105], v140 offset:4096
  ds_read_b64_tr_b16 v[106:107], v140 offset:5120
  v_mfma_f32_16x16x32_bf16 v[172:175], a[160:163], v[88:91], v[172:175]
  v_exp_f32 v146, v146
  v_mfma_f32_16x16x32_bf16 v[176:179], a[164:167], v[88:91], v[176:179]
  s_waitcnt lgkmcnt(6)
  v_exp_f32 v147, v147
  v_mfma_f32_16x16x32_bf16 v[168:171], a[168:171], v[92:95], v[168:171]
  ds_read_b64_tr_b16 v[88:89], v140 offset:8192
  ds_read_b64_tr_b16 v[90:91], v140 offset:9216
  v_mfma_f32_16x16x32_bf16 v[172:175], a[172:175], v[92:95], v[172:175]
  v_exp_f32 v152, v152
  v_mfma_f32_16x16x32_bf16 v[176:179], a[176:179], v[92:95], v[176:179]
  s_waitcnt lgkmcnt(6)
  v_exp_f32 v153, v153
  v_mfma_f32_16x16x32_bf16 v[168:171], a[180:183], v[96:99], v[168:171]
  ds_read_b64_tr_b16 v[92:93], v140 offset:12288
  ds_read_b64_tr_b16 v[94:95], v140 offset:13312
  v_mfma_f32_16x16x32_bf16 v[172:175], a[184:187], v[96:99], v[172:175]
  ds_read_b128 v[112:115], v12 offset:256
  v_fmac_f32 v148, v108, v80
  v_mfma_f32_16x16x32_bf16 v[176:179], a[188:191], v[96:99], v[176:179]
  s_waitcnt lgkmcnt(7)
  v_fmac_f32 v149, v108, v81
  v_fmac_f32 v150, v108, v82
  v_mfma_f32_16x16x32_bf16 v[180:183], a[0:3], v[100:103], 0
  ds_read_b64_tr_b16 v[96:97], v140 offset:16384
  ds_read_b64_tr_b16 v[98:99], v140 offset:17408
  v_mfma_f32_16x16x32_bf16 v[184:187], a[4:7], v[100:103], 0
  v_fmac_f32 v151, v108, v83
  v_fmac_f32 v154, v108, v86
  v_mfma_f32_16x16x32_bf16 v[188:191], a[8:11], v[100:103], 0
  s_waitcnt lgkmcnt(7)
  v_fmac_f32 v155, v108, v87
  v_fma_f32 v144, v144, v110, v110
  v_mfma_f32_16x16x32_bf16 v[180:183], a[12:15], v[104:107], v[180:183]
  ds_read_b64_tr_b16 v[100:101], v140 offset:20480
  ds_read_b64_tr_b16 v[102:103], v140 offset:21504
  v_mfma_f32_16x16x32_bf16 v[184:187], a[16:19], v[104:107], v[184:187]
  v_fma_f32 v145, v145, v110, v110
  v_fma_f32 v146, v146, v110, v110
  v_mfma_f32_16x16x32_bf16 v[188:191], a[20:23], v[104:107], v[188:191]
  s_waitcnt lgkmcnt(7)
  v_fma_f32 v147, v147, v110, v110
  v_fma_f32 v152, v152, v110, v110
  v_mfma_f32_16x16x32_bf16 v[180:183], a[24:27], v[88:91], v[180:183]
  ds_read_b64_tr_b16 v[104:105], v140 offset:24576
  ds_read_b64_tr_b16 v[106:107], v140 offset:25600
  v_mfma_f32_16x16x32_bf16 v[184:187], a[28:31], v[88:91], v[184:187]
  v_fma_f32 v153, v153, v110, v110
  v_mfma_f32_16x16x32_bf16 v[188:191], a[32:35], v[88:91], v[188:191]
  s_waitcnt lgkmcnt(7)
  v_rcp_f32 v144, v144
  v_mfma_f32_16x16x32_bf16 v[180:183], a[36:39], v[92:95], v[180:183]
  ds_read_b64_tr_b16 v[88:89], v140 offset:28672
  ds_read_b64_tr_b16 v[90:91], v140 offset:29696
  v_mfma_f32_16x16x32_bf16 v[184:187], a[40:43], v[92:95], v[184:187]
  v_rcp_f32 v145, v145
  v_mfma_f32_16x16x32_bf16 v[188:191], a[44:47], v[92:95], v[188:191]
  s_waitcnt lgkmcnt(6)
  v_rcp_f32 v146, v146
  v_mfma_f32_16x16x32_bf16 v[180:183], a[48:51], v[96:99], v[180:183]
  ds_read_b64_tr_b16 v[92:93], v140 offset:32768
  ds_read_b64_tr_b16 v[94:95], v140 offset:33792
  v_mfma_f32_16x16x32_bf16 v[184:187], a[52:55], v[96:99], v[184:187]
  v_rcp_f32 v147, v147
  v_mfma_f32_16x16x32_bf16 v[188:191], a[56:59], v[96:99], v[188:191]
  s_waitcnt lgkmcnt(6)
  v_rcp_f32 v152, v152
  v_mfma_f32_16x16x32_bf16 v[180:183], a[60:63], v[100:103], v[180:183]
  ds_read_b64_tr_b16 v[96:97], v140 offset:36864
  ds_read_b64_tr_b16 v[98:99], v140 offset:37888
  v_mfma_f32_16x16x32_bf16 v[184:187], a[64:67], v[100:103], v[184:187]
  v_rcp_f32 v153, v153
  v_mfma_f32_16x16x32_bf16 v[188:191], a[68:71], v[100:103], v[188:191]
  s_waitcnt lgkmcnt(6)
  s_add_u32 s69, s68, 0
  v_mul_f32 v144, v144, v148
  v_mul_f32 v145, v145, v149
  v_mfma_f32_16x16x32_bf16 v[180:183], a[72:75], v[104:107], v[180:183]
  ds_read_b64_tr_b16 v[100:101], v140 offset:40960
  ds_read_b64_tr_b16 v[102:103], v140 offset:41984
  v_mfma_f32_16x16x32_bf16 v[184:187], a[76:79], v[104:107], v[184:187]
  v_mul_f32 v146, v146, v150
  v_mul_f32 v147, v147, v151
  v_mfma_f32_16x16x32_bf16 v[188:191], a[80:83], v[104:107], v[188:191]
  s_waitcnt lgkmcnt(6)
  v_mul_f32 v152, v152, v154
  v_mul_f32 v153, v153, v155
  v_mfma_f32_16x16x32_bf16 v[180:183], a[84:87], v[88:91], v[180:183]
  ds_read_b64_tr_b16 v[104:105], v140 offset:45056
  ds_read_b64_tr_b16 v[106:107], v140 offset:46080
  v_mfma_f32_16x16x32_bf16 v[184:187], a[88:91], v[88:91], v[184:187]
  v_cvt_pk_bf16_f32 v148, v144, v145
  v_cvt_pk_bf16_f32 v149, v146, v147
  v_mfma_f32_16x16x32_bf16 v[188:191], a[92:95], v[88:91], v[188:191]
  s_waitcnt lgkmcnt(6)
  buffer_store_dwordx2 v[148:149], v13, s[44:47], s69 offen
  v_cvt_pk_bf16_f32 v150, v152, v153
  v_mfma_f32_16x16x32_bf16 v[180:183], a[96:99], v[92:95], v[180:183]
  ds_read_b64_tr_b16 v[88:89], v140 offset:49152
  ds_read_b64_tr_b16 v[90:91], v140 offset:50176
  v_mfma_f32_16x16x32_bf16 v[184:187], a[100:103], v[92:95], v[184:187]
  v_permlane16_swap_b32 v164, v166
  v_permlane16_swap_b32 v165, v167
  v_mfma_f32_16x16x32_bf16 v[188:191], a[104:107], v[92:95], v[188:191]
  s_waitcnt lgkmcnt(6)
  buffer_store_dword v150, v14, s[44:47], s69 offen offset:512
  s_add_u32 s21, s4, 2
  v_cmp_ne_u32 vcc, s21, v115
  v_mfma_f32_16x16x32_bf16 v[180:183], a[108:111], v[96:99], v[180:183]
  ds_read_b64_tr_b16 v[92:93], v140 offset:53248
  ds_read_b64_tr_b16 v[94:95], v140 offset:54272
  s_cbranch_vccnz L_rt1
L_bk1:
  v_mfma_f32_16x16x32_bf16 v[184:187], a[112:115], v[96:99], v[184:187]
  v_fmac_f32 v156, v112, v76
  v_fmac_f32 v157, v112, v77
  v_mfma_f32_16x16x32_bf16 v[188:191], a[116:119], v[96:99], v[188:191]
  s_waitcnt lgkmcnt(6)
  v_fmac_f32 v158, v112, v78
  v_fmac_f32 v159, v112, v79
  v_mfma_f32_16x16x32_bf16 v[180:183], a[120:123], v[100:103], v[180:183]
  ds_read_b64_tr_b16 v[96:97], v140 offset:57344
  ds_read_b64_tr_b16 v[98:99], v140 offset:58368
  v_mfma_f32_16x16x32_bf16 v[184:187], a[124:127], v[100:103], v[184:187]
  v_fmac_f32 v164, v112, v84
  v_fmac_f32 v165, v112, v85
  v_mfma_f32_16x16x32_bf16 v[188:191], a[128:131], v[100:103], v[188:191]
  s_waitcnt lgkmcnt(6)
  v_mul_f32 v156, v156, v113
  v_mul_f32 v157, v157, v113
  v_mfma_f32_16x16x32_bf16 v[180:183], a[132:135], v[104:107], v[180:183]
  ds_read_b64_tr_b16 v[100:101], v140 offset:61440
  ds_read_b64_tr_b16 v[102:103], v140 offset:62464
  v_mfma_f32_16x16x32_bf16 v[184:187], a[136:139], v[104:107], v[184:187]
  v_mul_f32 v158, v158, v113
  v_mul_f32 v159, v159, v113
  v_mfma_f32_16x16x32_bf16 v[188:191], a[140:143], v[104:107], v[188:191]
  s_waitcnt lgkmcnt(6)
  v_mul_f32 v164, v164, v113
  v_add_u32 v10, 65536, v10
  v_mfma_f32_16x16x32_bf16 v[180:183], a[144:147], v[88:91], v[180:183]
  s_waitcnt vmcnt(2)
  s_barrier
  ds_read_b64_tr_b16 v[104:105], v10 offset:0
  ds_read_b64_tr_b16 v[106:107], v10 offset:1024
  v_mfma_f32_16x16x32_bf16 v[184:187], a[148:151], v[88:91], v[184:187]
  v_mul_f32 v165, v165, v113
  v_mfma_f32_16x16x32_bf16 v[188:191], a[152:155], v[88:91], v[188:191]
  s_waitcnt lgkmcnt(6)
  v_exp_f32 v156, v156
  v_mfma_f32_16x16x32_bf16 v[180:183], a[156:159], v[92:95], v[180:183]
  ds_read_b64_tr_b16 v[88:89], v10 offset:4096
  ds_read_b64_tr_b16 v[90:91], v10 offset:5120
  v_mfma_f32_16x16x32_bf16 v[184:187], a[160:163], v[92:95], v[184:187]
  v_exp_f32 v157, v157
  v_mfma_f32_16x16x32_bf16 v[188:191], a[164:167], v[92:95], v[188:191]
  s_waitcnt lgkmcnt(6)
  v_exp_f32 v158, v158
  v_mfma_f32_16x16x32_bf16 v[180:183], a[168:171], v[96:99], v[180:183]
  ds_read_b64_tr_b16 v[92:93], v10 offset:8192
  ds_read_b64_tr_b16 v[94:95], v10 offset:9216
  v_mfma_f32_16x16x32_bf16 v[184:187], a[172:175], v[96:99], v[184:187]
  v_exp_f32 v159, v159
  v_mfma_f32_16x16x32_bf16 v[188:191], a[176:179], v[96:99], v[188:191]
  s_waitcnt lgkmcnt(6)
  v_add_u32 v138, 135168, v125
  v_mfma_f32_16x16x32_bf16 v[180:183], a[180:183], v[100:103], v[180:183]
  ds_read_b64_tr_b16 v[96:97], v10 offset:12288
  ds_read_b64_tr_b16 v[98:99], v10 offset:13312
  v_mfma_f32_16x16x32_bf16 v[184:187], a[184:187], v[100:103], v[184:187]
  v_exp_f32 v164, v164
  v_mfma_f32_16x16x32_bf16 v[188:191], a[188:191], v[100:103], v[188:191]
  s_waitcnt lgkmcnt(6)
  v_exp_f32 v165, v165
  v_mfma_f32_16x16x32_bf16 v[192:195], a[0:3], v[104:107], 0
  ds_read_b64_tr_b16 v[100:101], v10 offset:16384
  ds_read_b64_tr_b16 v[102:103], v10 offset:17408
  v_mfma_f32_16x16x32_bf16 v[196:199], a[4:7], v[104:107], 0
  ds_read_b64_tr_b16 v[128:129], v136 offset:0
  ds_read_b128 v[108:111], v12 offset:512
  v_mfma_f32_16x16x32_bf16 v[200:203], a[8:11], v[104:107], 0
  s_waitcnt lgkmcnt(8)
  ds_read_b64_tr_b16 v[130:131], v137 offset:512
  v_fmac_f32 v160, v112, v80
  v_mfma_f32_16x16x32_bf16 v[192:195], a[12:15], v[88:91], v[192:195]
  ds_read_b64_tr_b16 v[104:105], v10 offset:20480
  ds_read_b64_tr_b16 v[106:107], v10 offset:21504
  v_mfma_f32_16x16x32_bf16 v[196:199], a[16:19], v[88:91], v[196:199]
  ds_read_b64_tr_b16 v[132:133], v136 offset:2048
  v_fmac_f32 v161, v112, v81
  v_mfma_f32_16x16x32_bf16 v[200:203], a[20:23], v[88:91], v[200:203]
  s_waitcnt lgkmcnt(10)
  ds_read_b64_tr_b16 v[134:135], v137 offset:2560
  v_fmac_f32 v162, v112, v82
  v_mfma_f32_16x16x32_bf16 v[192:195], a[24:27], v[92:95], v[192:195]
  ds_read_b64_tr_b16 v[88:89], v10 offset:24576
  ds_read_b64_tr_b16 v[90:91], v10 offset:25600
  v_mfma_f32_16x16x32_bf16 v[196:199], a[28:31], v[92:95], v[196:199]
  ds_read_b64_tr_b16 a[192:193], v138 offset:0
  v_fmac_f32 v163, v112, v83
  v_mfma_f32_16x16x32_bf16 v[200:203], a[32:35], v[92:95], v[200:203]
  s_waitcnt lgkmcnt(12)
  ds_read_b64_tr_b16 a[194:195], v138 offset:512
  v_fmac_f32 v166, v112, v86
  v_mfma_f32_16x16x32_bf16 v[192:195], a[36:39], v[96:99], v[192:195]
  ds_read_b64_tr_b16 v[92:93], v10 offset:28672
  ds_read_b64_tr_b16 v[94:95], v10 offset:29696
  v_mfma_f32_16x16x32_bf16 v[196:199], a[40:43], v[96:99], v[196:199]
  ds_read_b64_tr_b16 a[196:197], v138 offset:4096
  v_fmac_f32 v167, v112, v87
  v_mfma_f32_16x16x32_bf16 v[200:203], a[44:47], v[96:99], v[200:203]
  s_waitcnt lgkmcnt(14)
  ds_read_b64_tr_b16 a[198:199], v138 offset:4608
  v_fma_f32 v156, v156, v114, v114
  v_mfma_f32_16x16x32_bf16 v[192:195], a[48:51], v[100:103], v[192:195]
  ds_read_b64_tr_b16 v[96:97], v10 offset:32768
  ds_read_b64_tr_b16 v[98:99], v10 offset:33792
  v_mfma_f32_16x16x32_bf16 v[196:199], a[52:55], v[100:103], v[196:199]
  ds_read_b64_tr_b16 a[200:201], v138 offset:8192
  v_fma_f32 v157, v157, v114, v114
  v_mfma_f32_16x16x32_bf16 v[200:203], a[56:59], v[100:103], v[200:203]
  s_waitcnt lgkmcnt(13)
  ds_read_b64_tr_b16 a[202:203], v138 offset:8704
  v_fma_f32 v158, v158, v114, v114
  v_mfma_f32_16x16x32_bf16 v[192:195], a[60:63], v[104:107], v[192:195]
  ds_read_b64_tr_b16 v[100:101], v10 offset:36864
  ds_read_b64_tr_b16 v[102:103], v10 offset:37888
  v_mfma_f32_16x16x32_bf16 v[196:199], a[64:67], v[104:107], v[196:199]
  ds_read_b64_tr_b16 a[204:205], v138 offset:12288
  v_fma_f32 v159, v159, v114, v114
  v_mfma_f32_16x16x32_bf16 v[200:203], a[68:71], v[104:107], v[200:203]
  s_waitcnt lgkmcnt(13)
  ds_read_b64_tr_b16 a[206:207], v138 offset:12800
  v_fma_f32 v164, v164, v114, v114
  v_mfma_f32_16x16x32_bf16 v[192:195], a[72:75], v[88:91], v[192:195]
  ds_read_b64_tr_b16 v[104:105], v10 offset:40960
  ds_read_b64_tr_b16 v[106:107], v10 offset:41984
  v_mfma_f32_16x16x32_bf16 v[196:199], a[76:79], v[88:91], v[196:199]
  ds_read_b64_tr_b16 a[208:209], v138 offset:16384
  v_fma_f32 v165, v165, v114, v114
  v_mfma_f32_16x16x32_bf16 v[200:203], a[80:83], v[88:91], v[200:203]
  s_waitcnt lgkmcnt(13)
  ds_read_b64_tr_b16 a[210:211], v138 offset:16896
  v_mfma_f32_16x16x32_bf16 v[192:195], a[84:87], v[92:95], v[192:195]
  ds_read_b64_tr_b16 v[88:89], v10 offset:45056
  ds_read_b64_tr_b16 v[90:91], v10 offset:46080
  v_mfma_f32_16x16x32_bf16 v[196:199], a[88:91], v[92:95], v[196:199]
  ds_read_b64_tr_b16 a[212:213], v138 offset:20480
  v_mfma_f32_16x16x32_bf16 v[200:203], a[92:95], v[92:95], v[200:203]
  s_waitcnt lgkmcnt(13)
  ds_read_b64_tr_b16 a[214:215], v138 offset:20992
  v_mfma_f32_16x16x32_bf16 v[192:195], a[96:99], v[96:99], v[192:195]
  ds_read_b64_tr_b16 v[92:93], v10 offset:49152
  ds_read_b64_tr_b16 v[94:95], v10 offset:50176
  v_mfma_f32_16x16x32_bf16 v[196:199], a[100:103], v[96:99], v[196:199]
  ds_read_b64_tr_b16 a[216:217], v138 offset:24576
  v_mfma_f32_16x16x32_bf16 v[200:203], a[104:107], v[96:99], v[200:203]
  s_waitcnt lgkmcnt(13)
  ds_read_b64_tr_b16 a[218:219], v138 offset:25088
  v_mfma_f32_16x16x32_bf16 v[192:195], a[108:111], v[100:103], v[192:195]
  ds_read_b64_tr_b16 v[96:97], v10 offset:53248
  ds_read_b64_tr_b16 v[98:99], v10 offset:54272
  v_mfma_f32_16x16x32_bf16 v[196:199], a[112:115], v[100:103], v[196:199]
  v_rcp_f32 v156, v156
  v_mfma_f32_16x16x32_bf16 v[200:203], a[116:119], v[100:103], v[200:203]
  s_waitcnt lgkmcnt(12)
  v_rcp_f32 v157, v157
  v_mfma_f32_16x16x32_bf16 v[192:195], a[120:123], v[104:107], v[192:195]
  ds_read_b64_tr_b16 v[100:101], v10 offset:57344
  ds_read_b64_tr_b16 v[102:103], v10 offset:58368
  v_mfma_f32_16x16x32_bf16 v[196:199], a[124:127], v[104:107], v[196:199]
  v_rcp_f32 v158, v158
  v_mfma_f32_16x16x32_bf16 v[200:203], a[128:131], v[104:107], v[200:203]
  s_waitcnt lgkmcnt(10)
  v_rcp_f32 v159, v159
  v_mfma_f32_16x16x32_bf16 v[192:195], a[132:135], v[88:91], v[192:195]
  ds_read_b64_tr_b16 v[104:105], v10 offset:61440
  ds_read_b64_tr_b16 v[106:107], v10 offset:62464
  v_mfma_f32_16x16x32_bf16 v[196:199], a[136:139], v[88:91], v[196:199]
  s_waitcnt lgkmcnt(6)
  s_barrier
  v_rcp_f32 v164, v164
  v_mfma_f32_16x16x32_bf16 v[200:203], a[140:143], v[88:91], v[200:203]
  s_add_u32 m0, s24, 0
  v_add_u32 v11, 65536, v11
  v_mfma_f32_16x16x32_bf16 v[192:195], a[144:147], v[92:95], v[192:195]
  s_add_u32 s77, s7, 112640
  ds_read_b64_tr_b16 v[88:89], v11 offset:0
  ds_read_b64_tr_b16 v[90:91], v11 offset:1024
  v_mfma_f32_16x16x32_bf16 v[196:199], a[148:151], v[92:95], v[196:199]
  buffer_load_dwordx4 v124, s[36:39], s77 offen  lds
  v_mfma_f32_16x16x32_bf16 v[200:203], a[152:155], v[92:95], v[200:203]
  s_waitcnt lgkmcnt(6)
  v_rcp_f32 v165, v165
  v_mfma_f32_16x16x32_bf16 v[192:195], a[156:159], v[96:99], v[192:195]
  ds_read_b64_tr_b16 v[92:93], v11 offset:4096
  ds_read_b64_tr_b16 v[94:95], v11 offset:5120
  s_add_u32 s69, s68, 45056
  v_mfma_f32_16x16x32_bf16 v[196:199], a[160:163], v[96:99], v[196:199]
  v_mul_f32 v156, v156, v160
  v_mul_f32 v157, v157, v161
  v_mfma_f32_16x16x32_bf16 v[200:203], a[164:167], v[96:99], v[200:203]
  s_waitcnt lgkmcnt(6)
  s_add_u32 m0, s24, 4096
  v_mul_f32 v158, v158, v162
  v_mul_f32 v159, v159, v163
  v_mfma_f32_16x16x32_bf16 v[192:195], a[168:171], v[100:103], v[192:195]
  s_add_u32 s77, s7, 129024
  ds_read_b64_tr_b16 v[96:97], v11 offset:8192
  ds_read_b64_tr_b16 v[98:99], v11 offset:9216
  v_mfma_f32_16x16x32_bf16 v[196:199], a[172:175], v[100:103], v[196:199]
  buffer_load_dwordx4 v124, s[36:39], s77 offen  lds
  v_mul_f32 v164, v164, v166
  v_mfma_f32_16x16x32_bf16 v[200:203], a[176:179], v[100:103], v[200:203]
  s_waitcnt lgkmcnt(6)
  v_mul_f32 v165, v165, v167
  v_cvt_pk_bf16_f32 v160, v156, v157
  v_mfma_f32_16x16x32_bf16 v[192:195], a[180:183], v[104:107], v[192:195]
  ds_read_b64_tr_b16 v[100:101], v11 offset:12288
  ds_read_b64_tr_b16 v[102:103], v11 offset:13312
  v_mfma_f32_16x16x32_bf16 v[196:199], a[184:187], v[104:107], v[196:199]
  v_cvt_pk_bf16_f32 v161, v158, v159
  v_mfma_f32_16x16x32_bf16 v[200:203], a[188:191], v[104:107], v[200:203]
  s_waitcnt lgkmcnt(6)
  s_add_u32 m0, s24, 8192
  buffer_store_dwordx2 v[160:161], v13, s[44:47], s69 offen
  v_cvt_pk_bf16_f32 v162, v164, v165
  v_mfma_f32_16x16x32_bf16 v[204:207], a[0:3], v[88:91], 0
  s_add_u32 s77, s7, 145408
  ds_read_b64_tr_b16 v[104:105], v11 offset:16384
  ds_read_b64_tr_b16 v[106:107], v11 offset:17408
  v_mfma_f32_16x16x32_bf16 v[208:211], a[4:7], v[88:91], 0
  buffer_load_dwordx4 v124, s[36:39], s77 offen  lds
  v_permlane16_swap_b32 v176, v178
  v_mfma_f32_16x16x32_bf16 v[212:215], a[8:11], v[88:91], 0
  s_waitcnt lgkmcnt(6)
  v_permlane16_swap_b32 v177, v179
  v_mfma_f32_16x16x32_bf16 v[204:207], a[12:15], v[92:95], v[204:207]
  ds_read_b64_tr_b16 v[88:89], v11 offset:20480
  ds_read_b64_tr_b16 v[90:91], v11 offset:21504
  v_mfma_f32_16x16x32_bf16 v[208:211], a[16:19], v[92:95], v[208:211]
  buffer_store_dword v162, v14, s[44:47], s69 offen offset:512
  s_add_u32 s21, s4, 3
  v_cmp_ne_u32 vcc, s21, v111
  v_mfma_f32_16x16x32_bf16 v[212:215], a[20:23], v[92:95], v[212:215]
  s_add_u32 m0, s24, 12288
  s_cbranch_vccnz L_rt2
L_bk2:
  v_fmac_f32 v168, v108, v76
  v_fmac_f32 v169, v108, v77
  s_waitcnt lgkmcnt(6)
  v_mfma_f32_16x16x32_bf16 v[204:207], a[24:27], v[96:99], v[204:207]
  s_add_u32 s77, s7, 161792
  ds_read_b64_tr_b16 v[92:93], v11 offset:24576
  ds_read_b64_tr_b16 v[94:95], v11 offset:25600
  v_mfma_f32_16x16x32_bf16 v[208:211], a[28:31], v[96:99], v[208:211]
  buffer_load_dwordx4 v124, s[36:39], s77 offen  lds
  v_fmac_f32 v170, v108, v78
  v_mfma_f32_16x16x32_bf16 v[212:215], a[32:35], v[96:99], v[212:215]
  s_waitcnt lgkmcnt(6)
  v_fmac_f32 v171, v108, v79
  v_fmac_f32 v176, v108, v84
  v_mfma_f32_16x16x32_bf16 v[204:207], a[36:39], v[100:103], v[204:207]
  ds_read_b64_tr_b16 v[96:97], v11 offset:28672
  ds_read_b64_tr_b16 v[98:99], v11 offset:29696
  v_mfma_f32_16x16x32_bf16 v[208:211], a[40:43], v[100:103], v[208:211]
  v_fmac_f32 v177, v108, v85
  v_mul_f32 v168, v168, v109
  v_mfma_f32_16x16x32_bf16 v[212:215], a[44:47], v[100:103], v[212:215]
  s_waitcnt lgkmcnt(6)
  s_add_u32 m0, s24, 16384
  v_mul_f32 v169, v169, v109
  v_mul_f32 v170, v170, v109
  v_mfma_f32_16x16x32_bf16 v[204:207], a[48:51], v[104:107], v[204:207]
  s_add_u32 s77, s7, 176128
  ds_read_b64_tr_b16 v[100:101], v11 offset:32768
  ds_read_b64_tr_b16 v[102:103], v11 offset:33792
  v_mfma_f32_16x16x32_bf16 v[208:211], a[52:55], v[104:107], v[208:211]
  buffer_load_dwordx4 v124, s[36:39], s77 offen  lds
  v_mul_f32 v171, v171, v109
  v_mfma_f32_16x16x32_bf16 v[212:215], a[56:59], v[104:107], v[212:215]
  s_waitcnt lgkmcnt(6)
  v_mul_f32 v176, v176, v109
  v_mul_f32 v177, v177, v109
  v_mfma_f32_16x16x32_bf16 v[204:207], a[60:63], v[88:91], v[204:207]
  ds_read_b64_tr_b16 v[104:105], v11 offset:36864
  ds_read_b64_tr_b16 v[106:107], v11 offset:37888
  v_mfma_f32_16x16x32_bf16 v[208:211], a[64:67], v[88:91], v[208:211]
  v_exp_f32 v168, v168
  v_mfma_f32_16x16x32_bf16 v[212:215], a[68:71], v[88:91], v[212:215]
  s_waitcnt lgkmcnt(6)
  s_add_u32 m0, s24, 20480
  v_exp_f32 v169, v169
  v_mfma_f32_16x16x32_bf16 v[204:207], a[72:75], v[92:95], v[204:207]
  s_add_u32 s77, s7, 192512
  ds_read_b64_tr_b16 v[88:89], v11 offset:40960
  ds_read_b64_tr_b16 v[90:91], v11 offset:41984
  v_mfma_f32_16x16x32_bf16 v[208:211], a[76:79], v[92:95], v[208:211]
  buffer_load_dwordx4 v124, s[36:39], s77 offen  lds
  v_mfma_f32_16x16x32_bf16 v[212:215], a[80:83], v[92:95], v[212:215]
  s_waitcnt lgkmcnt(6)
  v_exp_f32 v170, v170
  v_mfma_f32_16x16x32_bf16 v[204:207], a[84:87], v[96:99], v[204:207]
  ds_read_b64_tr_b16 v[92:93], v11 offset:45056
  ds_read_b64_tr_b16 v[94:95], v11 offset:46080
  v_mfma_f32_16x16x32_bf16 v[208:211], a[88:91], v[96:99], v[208:211]
  v_exp_f32 v171, v171
  v_mfma_f32_16x16x32_bf16 v[212:215], a[92:95], v[96:99], v[212:215]
  s_waitcnt lgkmcnt(6)
  s_add_u32 m0, s24, 24576
  v_exp_f32 v176, v176
  v_mfma_f32_16x16x32_bf16 v[204:207], a[96:99], v[100:103], v[204:207]
  s_add_u32 s77, s7, 208896
  ds_read_b64_tr_b16 v[96:97], v11 offset:49152
  ds_read_b64_tr_b16 v[98:99], v11 offset:50176
  v_mfma_f32_16x16x32_bf16 v[208:211], a[100:103], v[100:103], v[208:211]
  buffer_load_dwordx4 v124, s[36:39], s77 offen  lds
  v_mfma_f32_16x16x32_bf16 v[212:215], a[104:107], v[100:103], v[212:215]
  s_waitcnt lgkmcnt(6)
  v_exp_f32 v177, v177
  v_mfma_f32_16x16x32_bf16 v[204:207], a[108:111], v[104:107], v[204:207]
  ds_read_b64_tr_b16 v[100:101], v11 offset:53248
  ds_read_b64_tr_b16 v[102:103], v11 offset:54272
  v_mfma_f32_16x16x32_bf16 v[208:211], a[112:115], v[104:107], v[208:211]
  ds_read_b128 v[112:115], v12 offset:768
  v_fmac_f32 v172, v108, v80
  v_mfma_f32_16x16x32_bf16 v[212:215], a[116:119], v[104:107], v[212:215]
  s_waitcnt lgkmcnt(7)
  s_add_u32 m0, s24, 28672
  v_fmac_f32 v173, v108, v81
  v_fmac_f32 v174, v108, v82
  v_mfma_f32_16x16x32_bf16 v[204:207], a[120:123], v[88:91], v[204:207]
  s_add_u32 s77, s7, 225280
  ds_read_b64_tr_b16 v[104:105], v11 offset:57344
  ds_read_b64_tr_b16 v[106:107], v11 offset:58368
  v_mfma_f32_16x16x32_bf16 v[208:211], a[124:127], v[88:91], v[208:211]
  buffer_load_dwordx4 v124, s[36:39], s77 offen  lds
  v_fmac_f32 v175, v108, v83
  v_mfma_f32_16x16x32_bf16 v[212:215], a[128:131], v[88:91], v[212:215]
  s_waitcnt lgkmcnt(7)
  v_fmac_f32 v178, v108, v86
  v_fmac_f32 v179, v108, v87
  v_mfma_f32_16x16x32_bf16 v[204:207], a[132:135], v[92:95], v[204:207]
  ds_read_b64_tr_b16 v[88:89], v11 offset:61440
  ds_read_b64_tr_b16 v[90:91], v11 offset:62464
  v_mfma_f32_16x16x32_bf16 v[208:211], a[136:139], v[92:95], v[208:211]
  v_fma_f32 v168, v168, v110, v110
  v_fma_f32 v169, v169, v110, v110
  v_mfma_f32_16x16x32_bf16 v[212:215], a[140:143], v[92:95], v[212:215]
  s_waitcnt lgkmcnt(7)
  s_add_u32 m0, s24, 32768
  v_fma_f32 v170, v170, v110, v110
  v_add_u32 v139, 65536, v139
  v_mfma_f32_16x16x32_bf16 v[204:207], a[144:147], v[96:99], v[204:207]
  s_add_u32 s77, s7, 241664
  ds_read_b64_tr_b16 v[92:93], v139 offset:0
  ds_read_b64_tr_b16 v[94:95], v139 offset:1024
  v_mfma_f32_16x16x32_bf16 v[208:211], a[148:151], v[96:99], v[208:211]
  buffer_load_dwordx4 v124, s[36:39], s77 offen  lds
  v_fma_f32 v171, v171, v110, v110
  v_mfma_f32_16x16x32_bf16 v[212:215], a[152:155], v[96:99], v[212:215]
  s_waitcnt lgkmcnt(7)
  v_fma_f32 v176, v176, v110, v110
  v_fma_f32 v177, v177, v110, v110
  v_mfma_f32_16x16x32_bf16 v[204:207], a[156:159], v[100:103], v[204:207]
  ds_read_b64_tr_b16 v[96:97], v139 offset:4096
  ds_read_b64_tr_b16 v[98:99], v139 offset:5120
  v_mfma_f32_16x16x32_bf16 v[208:211], a[160:163], v[100:103], v[208:211]
  v_rcp_f32 v168, v168
  v_mfma_f32_16x16x32_bf16 v[212:215], a[164:167], v[100:103], v[212:215]
  s_waitcnt lgkmcnt(6)
  s_add_u32 m0, s24, 36864
  v_rcp_f32 v169, v169
  v_mfma_f32_16x16x32_bf16 v[204:207], a[168:171], v[104:107], v[204:207]
  s_add_u32 s77, s74, 258048
  ds_read_b64_tr_b16 v[100:101], v139 offset:8192
  ds_read_b64_tr_b16 v[102:103], v139 offset:9216
  v_mfma_f32_16x16x32_bf16 v[208:211], a[172:175], v[104:107], v[208:211]
  buffer_load_dwordx4 v124, s[36:39], s77 offen  lds
  v_mfma_f32_16x16x32_bf16 v[212:215], a[176:179], v[104:107], v[212:215]
  s_waitcnt lgkmcnt(6)
  v_rcp_f32 v170, v170
  v_mfma_f32_16x16x32_bf16 v[204:207], a[180:183], v[88:91], v[204:207]
  ds_read_b64_tr_b16 v[104:105], v139 offset:12288
  ds_read_b64_tr_b16 v[106:107], v139 offset:13312
  v_mfma_f32_16x16x32_bf16 v[208:211], a[184:187], v[88:91], v[208:211]
  v_rcp_f32 v171, v171
  v_mfma_f32_16x16x32_bf16 v[212:215], a[188:191], v[88:91], v[212:215]
  s_waitcnt lgkmcnt(6)
  s_add_u32 m0, s24, 40960
  v_rcp_f32 v176, v176
  v_mfma_f32_16x16x32_bf16 v[216:219], a[0:3], v[92:95], 0
  s_add_u32 s77, s7, 272384
  ds_read_b64_tr_b16 v[88:89], v139 offset:16384
  ds_read_b64_tr_b16 v[90:91], v139 offset:17408
  v_mfma_f32_16x16x32_bf16 v[220:223], a[4:7], v[92:95], 0
  buffer_load_dwordx4 v124, s[36:39], s77 offen  lds
  v_mfma_f32_16x16x32_bf16 v[224:227], a[8:11], v[92:95], 0
  s_waitcnt lgkmcnt(6)
  v_rcp_f32 v177, v177
  v_mfma_f32_16x16x32_bf16 v[216:219], a[12:15], v[96:99], v[216:219]
  ds_read_b64_tr_b16 v[92:93], v139 offset:20480
  ds_read_b64_tr_b16 v[94:95], v139 offset:21504
  s_add_u32 s69, s68, 90112
  v_mfma_f32_16x16x32_bf16 v[220:223], a[16:19], v[96:99], v[220:223]
  v_mul_f32 v168, v168, v172
  v_mul_f32 v169, v169, v173
  v_mfma_f32_16x16x32_bf16 v[224:227], a[20:23], v[96:99], v[224:227]
  s_waitcnt lgkmcnt(6)
  s_add_u32 m0, s24, 45056
  v_mul_f32 v170, v170, v174
  v_mul_f32 v171, v171, v175
  v_mfma_f32_16x16x32_bf16 v[216:219], a[24:27], v[100:103], v[216:219]
  s_add_u32 s77, s7, 288768
  ds_read_b64_tr_b16 v[96:97], v139 offset:24576
  ds_read_b64_tr_b16 v[98:99], v139 offset:25600
  v_mfma_f32_16x16x32_bf16 v[220:223], a[28:31], v[100:103], v[220:223]
  buffer_load_dwordx4 v124, s[36:39], s77 offen  lds
  v_mul_f32 v176, v176, v178
  v_mfma_f32_16x16x32_bf16 v[224:227], a[32:35], v[100:103], v[224:227]
  s_waitcnt lgkmcnt(6)
  v_mul_f32 v177, v177, v179
  v_cvt_pk_bf16_f32 v172, v168, v169
  v_mfma_f32_16x16x32_bf16 v[216:219], a[36:39], v[104:107], v[216:219]
  ds_read_b64_tr_b16 v[100:101], v139 offset:28672
  ds_read_b64_tr_b16 v[102:103], v139 offset:29696
  v_mfma_f32_16x16x32_bf16 v[220:223], a[40:43], v[104:107], v[220:223]
  v_cvt_pk_bf16_f32 v173, v170, v171
  v_mfma_f32_16x16x32_bf16 v[224:227], a[44:47], v[104:107], v[224:227]
  s_waitcnt lgkmcnt(6)
  s_add_u32 m0, s24, 49152
  buffer_store_dwordx2 v[172:173], v13, s[44:47], s69 offen
  v_cvt_pk_bf16_f32 v174, v176, v177
  v_mfma_f32_16x16x32_bf16 v[216:219], a[48:51], v[88:91], v[216:219]
  s_add_u32 s77, s7, 305152
  ds_read_b64_tr_b16 v[104:105], v139 offset:32768
  ds_read_b64_tr_b16 v[106:107], v139 offset:33792
  v_mfma_f32_16x16x32_bf16 v[220:223], a[52:55], v[88:91], v[220:223]
  buffer_load_dwordx4 v124, s[36:39], s77 offen  lds
  v_permlane16_swap_b32 v188, v190
  v_mfma_f32_16x16x32_bf16 v[224:227], a[56:59], v[88:91], v[224:227]
  s_waitcnt lgkmcnt(6)
  v_permlane16_swap_b32 v189, v191
  v_mfma_f32_16x16x32_bf16 v[216:219], a[60:63], v[92:95], v[216:219]
  ds_read_b64_tr_b16 v[88:89], v139 offset:36864
  ds_read_b64_tr_b16 v[90:91], v139 offset:37888
  v_mfma_f32_16x16x32_bf16 v[220:223], a[64:67], v[92:95], v[220:223]
  buffer_store_dword v174, v14, s[44:47], s69 offen offset:512
  s_add_u32 s21, s4, 4
  v_cmp_ne_u32 vcc, s21, v115
  v_mfma_f32_16x16x32_bf16 v[224:227], a[68:71], v[92:95], v[224:227]
  s_add_u32 m0, s24, 53248
  s_cbranch_vccnz L_rt3
L_bk3:
  v_fmac_f32 v180, v112, v76
  v_fmac_f32 v181, v112, v77
  s_waitcnt lgkmcnt(6)
  v_mfma_f32_16x16x32_bf16 v[216:219], a[72:75], v[96:99], v[216:219]
  s_add_u32 s77, s7, 321536
  ds_read_b64_tr_b16 v[92:93], v139 offset:40960
  ds_read_b64_tr_b16 v[94:95], v139 offset:41984
  v_mfma_f32_16x16x32_bf16 v[220:223], a[76:79], v[96:99], v[220:223]
  buffer_load_dwordx4 v124, s[36:39], s77 offen  lds
  v_fmac_f32 v182, v112, v78
  v_mfma_f32_16x16x32_bf16 v[224:227], a[80:83], v[96:99], v[224:227]
  s_waitcnt lgkmcnt(6)
  v_fmac_f32 v183, v112, v79
  v_fmac_f32 v188, v112, v84
  v_mfma_f32_16x16x32_bf16 v[216:219], a[84:87], v[100:103], v[216:219]
  ds_read_b64_tr_b16 v[96:97], v139 offset:45056
  ds_read_b64_tr_b16 v[98:99], v139 offset:46080
  v_mfma_f32_16x16x32_bf16 v[220:223], a[88:91], v[100:103], v[220:223]
  v_fmac_f32 v189, v112, v85
  v_mul_f32 v180, v180, v113
  v_mfma_f32_16x16x32_bf16 v[224:227], a[92:95], v[100:103], v[224:227]
  s_waitcnt lgkmcnt(6)
  s_add_u32 m0, s24, 57344
  v_mul_f32 v181, v181, v113
  v_mul_f32 v182, v182, v113
  v_mfma_f32_16x16x32_bf16 v[216:219], a[96:99], v[104:107], v[216:219]
  s_add_u32 s77, s7, 337920
  ds_read_b64_tr_b16 v[100:101], v139 offset:49152
  ds_read_b64_tr_b16 v[102:103], v139 offset:50176
  v_mfma_f32_16x16x32_bf16 v[220:223], a[100:103], v[104:107], v[220:223]
  buffer_load_dwordx4 v124, s[36:39], s77 offen  lds
  v_mul_f32 v183, v183, v113
  v_mfma_f32_16x16x32_bf16 v[224:227], a[104:107], v[104:107], v[224:227]
  s_waitcnt lgkmcnt(6)
  v_mul_f32 v188, v188, v113
  v_mul_f32 v189, v189, v113
  v_mfma_f32_16x16x32_bf16 v[216:219], a[108:111], v[88:91], v[216:219]
  ds_read_b64_tr_b16 v[104:105], v139 offset:53248
  ds_read_b64_tr_b16 v[106:107], v139 offset:54272
  v_mfma_f32_16x16x32_bf16 v[220:223], a[112:115], v[88:91], v[220:223]
  v_exp_f32 v180, v180
  v_mfma_f32_16x16x32_bf16 v[224:227], a[116:119], v[88:91], v[224:227]
  s_waitcnt lgkmcnt(6)
  s_add_u32 m0, s24, 61440
  v_exp_f32 v181, v181
  v_mfma_f32_16x16x32_bf16 v[216:219], a[120:123], v[92:95], v[216:219]
  s_add_u32 s77, s9, 352256
  ds_read_b64_tr_b16 v[88:89], v139 offset:57344
  ds_read_b64_tr_b16 v[90:91], v139 offset:58368
  v_mfma_f32_16x16x32_bf16 v[220:223], a[124:127], v[92:95], v[220:223]
  buffer_load_dwordx4 v124, s[36:39], s77 offen  lds
  v_mfma_f32_16x16x32_bf16 v[224:227], a[128:131], v[92:95], v[224:227]
  s_waitcnt lgkmcnt(6)
  v_exp_f32 v182, v182
  v_mfma_f32_16x16x32_bf16 v[216:219], a[132:135], v[96:99], v[216:219]
  ds_read_b64_tr_b16 v[92:93], v139 offset:61440
  ds_read_b64_tr_b16 v[94:95], v139 offset:62464
  v_mfma_f32_16x16x32_bf16 v[220:223], a[136:139], v[96:99], v[220:223]
  v_exp_f32 v183, v183
  v_mfma_f32_16x16x32_bf16 v[224:227], a[140:143], v[96:99], v[224:227]
  s_waitcnt lgkmcnt(6)
  s_add_u32 m0, s24, 135168
  v_add_u32 v140, 65536, v140
  v_mfma_f32_16x16x32_bf16 v[216:219], a[144:147], v[100:103], v[216:219]
  s_add_u32 s77, s9, 368640
  ds_read_b64_tr_b16 v[96:97], v140 offset:0
  ds_read_b64_tr_b16 v[98:99], v140 offset:1024
  v_mfma_f32_16x16x32_bf16 v[220:223], a[148:151], v[100:103], v[220:223]
  buffer_load_dwordx4 v124, s[36:39], s77 offen  lds
  v_mfma_f32_16x16x32_bf16 v[224:227], a[152:155], v[100:103], v[224:227]
  s_waitcnt lgkmcnt(6)
  v_exp_f32 v188, v188
  v_mfma_f32_16x16x32_bf16 v[216:219], a[156:159], v[104:107], v[216:219]
  ds_read_b64_tr_b16 v[100:101], v140 offset:4096
  ds_read_b64_tr_b16 v[102:103], v140 offset:5120
  v_mfma_f32_16x16x32_bf16 v[220:223], a[160:163], v[104:107], v[220:223]
  v_exp_f32 v189, v189
  v_mfma_f32_16x16x32_bf16 v[224:227], a[164:167], v[104:107], v[224:227]
  s_waitcnt lgkmcnt(6)
  s_add_u32 m0, s24, 139264
  ds_read_b128 v[108:111], v12 offset:1024
  v_fmac_f32 v184, v112, v80
  v_mfma_f32_16x16x32_bf16 v[216:219], a[168:171], v[88:91], v[216:219]
  s_add_u32 s77, s9, 385024
  ds_read_b64_tr_b16 v[104:105], v140 offset:8192
  ds_read_b64_tr_b16 v[106:107], v140 offset:9216
  v_mfma_f32_16x16x32_bf16 v[220:223], a[172:175], v[88:91], v[220:223]
  buffer_load_dwordx4 v124, s[36:39], s77 offen  lds
  v_fmac_f32 v185, v112, v81
  v_mfma_f32_16x16x32_bf16 v[224:227], a[176:179], v[88:91], v[224:227]
  s_waitcnt lgkmcnt(7)
  v_fmac_f32 v186, v112, v82
  v_fmac_f32 v187, v112, v83
  v_mfma_f32_16x16x32_bf16 v[216:219], a[180:183], v[92:95], v[216:219]
  ds_read_b64_tr_b16 v[88:89], v140 offset:12288
  ds_read_b64_tr_b16 v[90:91], v140 offset:13312
  v_mfma_f32_16x16x32_bf16 v[220:223], a[184:187], v[92:95], v[220:223]
  v_fmac_f32 v190, v112, v86
  v_fmac_f32 v191, v112, v87
  v_mfma_f32_16x16x32_bf16 v[224:227], a[188:191], v[92:95], v[224:227]
  s_waitcnt lgkmcnt(7)
  s_add_u32 m0, s24, 143360
  v_fma_f32 v180, v180, v114, v114
  v_fma_f32 v181, v181, v114, v114
  v_mfma_f32_16x16x32_bf16 v[228:231], a[0:3], v[96:99], 0
  s_add_u32 s77, s9, 401408
  ds_read_b64_tr_b16 v[92:93], v140 offset:16384
  ds_read_b64_tr_b16 v[94:95], v140 offset:17408
  v_mfma_f32_16x16x32_bf16 v[232:235], a[4:7], v[96:99], 0
  buffer_load_dwordx4 v124, s[36:39], s77 offen  lds
  v_fma_f32 v182, v182, v114, v114
  v_mfma_f32_16x16x32_bf16 v[236:239], a[8:11], v[96:99], 0
  s_waitcnt lgkmcnt(7)
  v_fma_f32 v183, v183, v114, v114
  v_fma_f32 v188, v188, v114, v114
  v_mfma_f32_16x16x32_bf16 v[228:231], a[12:15], v[100:103], v[228:231]
  ds_read_b64_tr_b16 v[96:97], v140 offset:20480
  ds_read_b64_tr_b16 v[98:99], v140 offset:21504
  v_mfma_f32_16x16x32_bf16 v[232:235], a[16:19], v[100:103], v[232:235]
  v_fma_f32 v189, v189, v114, v114
  v_mfma_f32_16x16x32_bf16 v[236:239], a[20:23], v[100:103], v[236:239]
  s_waitcnt lgkmcnt(6)
  s_add_u32 m0, s24, 147456
  v_rcp_f32 v180, v180
  v_mfma_f32_16x16x32_bf16 v[228:231], a[24:27], v[104:107], v[228:231]
  s_add_u32 s77, s9, 417792
  ds_read_b64_tr_b16 v[100:101], v140 offset:24576
  ds_read_b64_tr_b16 v[102:103], v140 offset:25600
  v_mfma_f32_16x16x32_bf16 v[232:235], a[28:31], v[104:107], v[232:235]
  buffer_load_dwordx4 v124, s[36:39], s77 offen  lds
  v_mfma_f32_16x16x32_bf16 v[236:239], a[32:35], v[104:107], v[236:239]
  s_waitcnt lgkmcnt(6)
  v_rcp_f32 v181, v181
  v_mfma_f32_16x16x32_bf16 v[228:231], a[36:39], v[88:91], v[228:231]
  ds_read_b64_tr_b16 v[104:105], v140 offset:28672
  ds_read_b64_tr_b16 v[106:107], v140 offset:29696
  v_mfma_f32_16x16x32_bf16 v[232:235], a[40:43], v[88:91], v[232:235]
  v_rcp_f32 v182, v182
  v_mfma_f32_16x16x32_bf16 v[236:239], a[44:47], v[88:91], v[236:239]
  s_waitcnt lgkmcnt(6)
  s_add_u32 m0, s24, 151552
  v_rcp_f32 v183, v183
  v_mfma_f32_16x16x32_bf16 v[228:231], a[48:51], v[92:95], v[228:231]
  s_add_u32 s77, s10, 434176
  ds_read_b64_tr_b16 v[88:89], v140 offset:32768
  ds_read_b64_tr_b16 v[90:91], v140 offset:33792
  v_mfma_f32_16x16x32_bf16 v[232:235], a[52:55], v[92:95], v[232:235]
  buffer_load_dwordx4 v124, s[36:39], s77 offen  lds
  v_mfma_f32_16x16x32_bf16 v[236:239], a[56:59], v[92:95], v[236:239]
  s_waitcnt lgkmcnt(6)
  v_rcp_f32 v188, v188
  v_mfma_f32_16x16x32_bf16 v[228:231], a[60:63], v[96:99], v[228:231]
  ds_read_b64_tr_b16 v[92:93], v140 offset:36864
  ds_read_b64_tr_b16 v[94:95], v140 offset:37888
  v_mfma_f32_16x16x32_bf16 v[232:235], a[64:67], v[96:99], v[232:235]
  v_rcp_f32 v189, v189
  v_mfma_f32_16x16x32_bf16 v[236:239], a[68:71], v[96:99], v[236:239]
  s_waitcnt lgkmcnt(6)
  s_add_u32 m0, s24, 155648
  s_add_u32 s69, s68, 135168
  v_mul_f32 v180, v180, v184
  v_mul_f32 v181, v181, v185
  v_mfma_f32_16x16x32_bf16 v[228:231], a[72:75], v[100:103], v[228:231]
  s_add_u32 s77, s9, 448512
  ds_read_b64_tr_b16 v[96:97], v140 offset:40960
  ds_read_b64_tr_b16 v[98:99], v140 offset:41984
  v_mfma_f32_16x16x32_bf16 v[232:235], a[76:79], v[100:103], v[232:235]
  buffer_load_dwordx4 v124, s[36:39], s77 offen  lds
  v_mul_f32 v182, v182, v186
  v_mfma_f32_16x16x32_bf16 v[236:239], a[80:83], v[100:103], v[236:239]
  s_waitcnt lgkmcnt(6)
  v_mul_f32 v183, v183, v187
  v_mul_f32 v188, v188, v190
  v_mfma_f32_16x16x32_bf16 v[228:231], a[84:87], v[104:107], v[228:231]
  ds_read_b64_tr_b16 v[100:101], v140 offset:45056
  ds_read_b64_tr_b16 v[102:103], v140 offset:46080
  v_mfma_f32_16x16x32_bf16 v[232:235], a[88:91], v[104:107], v[232:235]
  v_mul_f32 v189, v189, v191
  v_cvt_pk_bf16_f32 v184, v180, v181
  v_mfma_f32_16x16x32_bf16 v[236:239], a[92:95], v[104:107], v[236:239]
  s_waitcnt lgkmcnt(6)
  s_add_u32 m0, s24, 159744
  v_cvt_pk_bf16_f32 v185, v182, v183
  v_mfma_f32_16x16x32_bf16 v[228:231], a[96:99], v[88:91], v[228:231]
  s_add_u32 s77, s9, 464896
  ds_read_b64_tr_b16 v[104:105], v140 offset:49152
  ds_read_b64_tr_b16 v[106:107], v140 offset:50176
  v_mfma_f32_16x16x32_bf16 v[232:235], a[100:103], v[88:91], v[232:235]
  buffer_load_dwordx4 v124, s[36:39], s77 offen  lds
  v_mfma_f32_16x16x32_bf16 v[236:239], a[104:107], v[88:91], v[236:239]
  s_waitcnt lgkmcnt(6)
  buffer_store_dwordx2 v[184:185], v13, s[44:47], s69 offen
  v_cvt_pk_bf16_f32 v186, v188, v189
  v_mfma_f32_16x16x32_bf16 v[228:231], a[108:111], v[92:95], v[228:231]
  ds_read_b64_tr_b16 v[88:89], v140 offset:53248
  ds_read_b64_tr_b16 v[90:91], v140 offset:54272
  v_mfma_f32_16x16x32_bf16 v[232:235], a[112:115], v[92:95], v[232:235]
  v_permlane16_swap_b32 v200, v202
  v_permlane16_swap_b32 v201, v203
  v_mfma_f32_16x16x32_bf16 v[236:239], a[116:119], v[92:95], v[236:239]
  s_waitcnt lgkmcnt(6)
  buffer_store_dword v186, v14, s[44:47], s69 offen offset:512
  s_add_u32 s21, s4, 5
  v_cmp_ne_u32 vcc, s21, v111
  v_mfma_f32_16x16x32_bf16 v[228:231], a[120:123], v[96:99], v[228:231]
  ds_read_b64_tr_b16 v[92:93], v140 offset:57344
  ds_read_b64_tr_b16 v[94:95], v140 offset:58368
  s_cbranch_vccnz L_rt4
L_bk4:
  v_mfma_f32_16x16x32_bf16 v[232:235], a[124:127], v[96:99], v[232:235]
  v_fmac_f32 v192, v108, v76
  v_fmac_f32 v193, v108, v77
  v_mfma_f32_16x16x32_bf16 v[236:239], a[128:131], v[96:99], v[236:239]
  s_waitcnt lgkmcnt(6)
  v_fmac_f32 v194, v108, v78
  v_fmac_f32 v195, v108, v79
  v_mfma_f32_16x16x32_bf16 v[228:231], a[132:135], v[100:103], v[228:231]
  ds_read_b64_tr_b16 v[96:97], v140 offset:61440
  ds_read_b64_tr_b16 v[98:99], v140 offset:62464
  v_mfma_f32_16x16x32_bf16 v[232:235], a[136:139], v[100:103], v[232:235]
  v_fmac_f32 v200, v108, v84
  v_fmac_f32 v201, v108, v85
  v_mfma_f32_16x16x32_bf16 v[236:239], a[140:143], v[100:103], v[236:239]
  s_waitcnt lgkmcnt(6)
  v_mul_f32 v192, v192, v109
  v_mul_f32 v193, v193, v109
  v_mfma_f32_16x16x32_bf16 v[228:231], a[144:147], v[104:107], v[228:231]
  v_mul_f32 v194, v194, v109
  v_mul_f32 v195, v195, v109
  v_mfma_f32_16x16x32_bf16 v[232:235], a[148:151], v[104:107], v[232:235]
  v_mul_f32 v200, v200, v109
  v_mul_f32 v201, v201, v109
  v_mfma_f32_16x16x32_bf16 v[236:239], a[152:155], v[104:107], v[236:239]
  s_waitcnt lgkmcnt(4)
  v_exp_f32 v192, v192
  v_mfma_f32_16x16x32_bf16 v[228:231], a[156:159], v[88:91], v[228:231]
  v_exp_f32 v193, v193
  v_mfma_f32_16x16x32_bf16 v[232:235], a[160:163], v[88:91], v[232:235]
  v_exp_f32 v194, v194
  v_mfma_f32_16x16x32_bf16 v[236:239], a[164:167], v[88:91], v[236:239]
  s_waitcnt lgkmcnt(2)
  v_exp_f32 v195, v195
  v_mfma_f32_16x16x32_bf16 v[228:231], a[168:171], v[92:95], v[228:231]
  v_exp_f32 v200, v200
  v_mfma_f32_16x16x32_bf16 v[232:235], a[172:175], v[92:95], v[232:235]
  v_exp_f32 v201, v201
  v_mfma_f32_16x16x32_bf16 v[236:239], a[176:179], v[92:95], v[236:239]
  s_waitcnt lgkmcnt(0)
  ds_read_b128 v[112:115], v12 offset:1280
  v_fmac_f32 v196, v108, v80
  v_mfma_f32_16x16x32_bf16 v[228:231], a[180:183], v[96:99], v[228:231]
  v_fmac_f32 v197, v108, v81
  v_fmac_f32 v198, v108, v82
  v_mfma_f32_16x16x32_bf16 v[232:235], a[184:187], v[96:99], v[232:235]
  v_fmac_f32 v199, v108, v83
  v_fmac_f32 v202, v108, v86
  v_mfma_f32_16x16x32_bf16 v[236:239], a[188:191], v[96:99], v[236:239]
  v_fmac_f32 v203, v108, v87
  v_fma_f32 v192, v192, v110, v110
  v_fma_f32 v193, v193, v110, v110
  v_fma_f32 v194, v194, v110, v110
  v_fma_f32 v195, v195, v110, v110
  v_fma_f32 v200, v200, v110, v110
  v_fma_f32 v201, v201, v110, v110
  v_rcp_f32 v192, v192
  v_rcp_f32 v193, v193
  v_rcp_f32 v194, v194
  v_rcp_f32 v195, v195
  v_rcp_f32 v200, v200
  v_rcp_f32 v201, v201
  s_add_u32 s69, s68, 180224
  v_mul_f32 v192, v192, v196
  v_mul_f32 v193, v193, v197
  v_mul_f32 v194, v194, v198
  v_mul_f32 v195, v195, v199
  v_mul_f32 v200, v200, v202
  v_mul_f32 v201, v201, v203
  v_cvt_pk_bf16_f32 v196, v192, v193
  v_cvt_pk_bf16_f32 v197, v194, v195
  buffer_store_dwordx2 v[196:197], v13, s[44:47], s69 offen
  v_cvt_pk_bf16_f32 v198, v200, v201
  v_permlane16_swap_b32 v212, v214
  v_permlane16_swap_b32 v213, v215
  buffer_store_dword v198, v14, s[44:47], s69 offen offset:512
  s_add_u32 s21, s4, 6
  s_waitcnt lgkmcnt(0)
  v_cmp_ne_u32 vcc, s21, v115
  s_cbranch_vccnz L_rt5
L_bk5:
  v_pk_fma_f32 v[204:205], v[112:113], v[76:77], v[204:205] op_sel_hi:[0,1,1]
  v_pk_fma_f32 v[206:207], v[112:113], v[78:79], v[206:207] op_sel_hi:[0,1,1]
  v_pk_fma_f32 v[212:213], v[112:113], v[84:85], v[212:213] op_sel_hi:[0,1,1]
  v_pk_mul_f32 v[204:205], v[204:205], v[112:113] op_sel:[0,1]
  v_pk_mul_f32 v[206:207], v[206:207], v[112:113] op_sel:[0,1]
  v_pk_mul_f32 v[212:213], v[212:213], v[112:113] op_sel:[0,1]
  v_exp_f32 v204, v204
  v_exp_f32 v205, v205
  v_exp_f32 v206, v206
  v_exp_f32 v207, v207
  v_exp_f32 v212, v212
  v_exp_f32 v213, v213
  ds_read_b128 v[108:111], v12 offset:1536
  v_pk_fma_f32 v[208:209], v[112:113], v[80:81], v[208:209] op_sel_hi:[0,1,1]
  v_pk_fma_f32 v[210:211], v[112:113], v[82:83], v[210:211] op_sel_hi:[0,1,1]
  v_pk_fma_f32 v[214:215], v[112:113], v[86:87], v[214:215] op_sel_hi:[0,1,1]
  v_pk_fma_f32 v[204:205], v[204:205], v[114:115], v[114:115] op_sel_hi:[1,0,0]
  v_pk_fma_f32 v[206:207], v[206:207], v[114:115], v[114:115] op_sel_hi:[1,0,0]
  v_pk_fma_f32 v[212:213], v[212:213], v[114:115], v[114:115] op_sel_hi:[1,0,0]
  v_rcp_f32 v204, v204
  v_rcp_f32 v205, v205
  v_rcp_f32 v206, v206
  v_rcp_f32 v207, v207
  v_rcp_f32 v212, v212
  v_rcp_f32 v213, v213
  s_add_u32 s69, s68, 225280
  v_pk_mul_f32 v[204:205], v[204:205], v[208:209]
  v_pk_mul_f32 v[206:207], v[206:207], v[210:211]
  v_pk_mul_f32 v[212:213], v[212:213], v[214:215]
  v_cvt_pk_bf16_f32 v208, v204, v205
  v_cvt_pk_bf16_f32 v209, v206, v207
  buffer_store_dwordx2 v[208:209], v13, s[44:47], s69 offen
  v_cvt_pk_bf16_f32 v210, v212, v213
  v_permlane16_swap_b32 v224, v226
  v_permlane16_swap_b32 v225, v227
  buffer_store_dword v210, v14, s[44:47], s69 offen offset:512
  s_add_u32 s21, s4, 7
  s_waitcnt lgkmcnt(0)
  v_cmp_ne_u32 vcc, s21, v111
  s_cbranch_vccnz L_rt6
L_bk6:
  v_pk_fma_f32 v[216:217], v[108:109], v[76:77], v[216:217] op_sel_hi:[0,1,1]
  v_pk_fma_f32 v[218:219], v[108:109], v[78:79], v[218:219] op_sel_hi:[0,1,1]
  v_pk_fma_f32 v[224:225], v[108:109], v[84:85], v[224:225] op_sel_hi:[0,1,1]
  v_pk_mul_f32 v[216:217], v[216:217], v[108:109] op_sel:[0,1]
  v_pk_mul_f32 v[218:219], v[218:219], v[108:109] op_sel:[0,1]
  v_pk_mul_f32 v[224:225], v[224:225], v[108:109] op_sel:[0,1]
  v_exp_f32 v216, v216
  v_exp_f32 v217, v217
  v_exp_f32 v218, v218
  v_exp_f32 v219, v219
  v_exp_f32 v224, v224
  v_exp_f32 v225, v225
  ds_read_b128 v[112:115], v12 offset:1792
  v_pk_fma_f32 v[220:221], v[108:109], v[80:81], v[220:221] op_sel_hi:[0,1,1]
  v_pk_fma_f32 v[222:223], v[108:109], v[82:83], v[222:223] op_sel_hi:[0,1,1]
  v_pk_fma_f32 v[226:227], v[108:109], v[86:87], v[226:227] op_sel_hi:[0,1,1]
  v_pk_fma_f32 v[216:217], v[216:217], v[110:111], v[110:111] op_sel_hi:[1,0,0]
  v_pk_fma_f32 v[218:219], v[218:219], v[110:111], v[110:111] op_sel_hi:[1,0,0]
  v_pk_fma_f32 v[224:225], v[224:225], v[110:111], v[110:111] op_sel_hi:[1,0,0]
  v_rcp_f32 v216, v216
  v_rcp_f32 v217, v217
  v_rcp_f32 v218, v218
  v_rcp_f32 v219, v219
  v_rcp_f32 v224, v224
  v_rcp_f32 v225, v225
  s_add_u32 s69, s68, 270336
  v_pk_mul_f32 v[216:217], v[216:217], v[220:221]
  v_pk_mul_f32 v[218:219], v[218:219], v[222:223]
  v_pk_mul_f32 v[224:225], v[224:225], v[226:227]
  v_cvt_pk_bf16_f32 v220, v216, v217
  v_cvt_pk_bf16_f32 v221, v218, v219
  buffer_store_dwordx2 v[220:221], v13, s[44:47], s69 offen
  v_cvt_pk_bf16_f32 v222, v224, v225
  v_permlane16_swap_b32 v236, v238
  v_permlane16_swap_b32 v237, v239
  buffer_store_dword v222, v14, s[44:47], s69 offen offset:512
  s_add_u32 s21, s4, 8
  s_waitcnt lgkmcnt(0)
  v_cmp_ne_u32 vcc, s21, v115
  s_cbranch_vccnz L_rt7
L_bk7:
  v_pk_fma_f32 v[228:229], v[112:113], v[76:77], v[228:229] op_sel_hi:[0,1,1]
  v_pk_fma_f32 v[230:231], v[112:113], v[78:79], v[230:231] op_sel_hi:[0,1,1]
  v_pk_fma_f32 v[236:237], v[112:113], v[84:85], v[236:237] op_sel_hi:[0,1,1]
  v_pk_mul_f32 v[228:229], v[228:229], v[112:113] op_sel:[0,1]
  v_pk_mul_f32 v[230:231], v[230:231], v[112:113] op_sel:[0,1]
  v_pk_mul_f32 v[236:237], v[236:237], v[112:113] op_sel:[0,1]
  v_exp_f32 v228, v228
  v_exp_f32 v229, v229
  v_exp_f32 v230, v230
  v_exp_f32 v231, v231
  v_exp_f32 v236, v236
  v_exp_f32 v237, v237
  v_pk_fma_f32 v[232:233], v[112:113], v[80:81], v[232:233] op_sel_hi:[0,1,1]
  v_pk_fma_f32 v[234:235], v[112:113], v[82:83], v[234:235] op_sel_hi:[0,1,1]
  v_pk_fma_f32 v[238:239], v[112:113], v[86:87], v[238:239] op_sel_hi:[0,1,1]
  v_pk_fma_f32 v[228:229], v[228:229], v[114:115], v[114:115] op_sel_hi:[1,0,0]
  v_pk_fma_f32 v[230:231], v[230:231], v[114:115], v[114:115] op_sel_hi:[1,0,0]
  v_pk_fma_f32 v[236:237], v[236:237], v[114:115], v[114:115] op_sel_hi:[1,0,0]
  v_rcp_f32 v228, v228
  v_rcp_f32 v229, v229
  v_rcp_f32 v230, v230
  v_rcp_f32 v231, v231
  v_rcp_f32 v236, v236
  v_rcp_f32 v237, v237
  s_add_u32 s69, s68, 315392
  v_pk_mul_f32 v[228:229], v[228:229], v[232:233]
  v_pk_mul_f32 v[230:231], v[230:231], v[234:235]
  v_pk_mul_f32 v[236:237], v[236:237], v[238:239]
  v_cvt_pk_bf16_f32 v232, v228, v229
  v_cvt_pk_bf16_f32 v233, v230, v231
  buffer_store_dwordx2 v[232:233], v13, s[44:47], s69 offen
  v_cvt_pk_bf16_f32 v234, v236, v237
  buffer_store_dword v234, v14, s[44:47], s69 offen offset:512
  s_branch L_p2done
.p2align 6
L_warm3:
  s_branch L_warm3r
L_p2w3:
  v_xor_b32 v10, 0, v9
  v_xor_b32 v11, 32, v9
  v_xor_b32 v139, 64, v9
  v_xor_b32 v140, 96, v9
  ds_read_b64_tr_b16 v[88:89], v10 offset:0
  ds_read_b64_tr_b16 v[90:91], v10 offset:1024
  ds_read_b64_tr_b16 v[92:93], v11 offset:0
  ds_read_b64_tr_b16 v[94:95], v11 offset:1024
  ds_read_b64_tr_b16 v[96:97], v10 offset:4096
  ds_read_b64_tr_b16 v[98:99], v10 offset:5120
  ds_read_b64_tr_b16 v[100:101], v11 offset:4096
  ds_read_b64_tr_b16 v[102:103], v11 offset:5120
  s_waitcnt lgkmcnt(6)
  v_mfma_f32_16x16x32_bf16 v[144:147], a[0:3], v[88:91], 0
  ds_read_b64_tr_b16 v[104:105], v10 offset:8192
  ds_read_b64_tr_b16 v[106:107], v10 offset:9216
  v_mfma_f32_16x16x32_bf16 v[148:151], a[4:7], v[88:91], 0
  s_add_u32 s77, s76, 49152
  s_and_b32 s77, s77, 0xffff
  s_add_u32 m0, s24, 49152
  s_nop 0
  buffer_load_dwordx4 v126, s[44:47], s77 offen sc1 lds
  v_bfe_u32 v40, v0, 2, 1
  v_mfma_f32_16x16x32_bf16 v[152:155], v[88:91], v[88:91], 0
  s_waitcnt lgkmcnt(6)
  v_lshlrev_b32 v40, 3, v40
  v_bfe_u32 v41, v0, 5, 1
  v_mfma_f32_16x16x32_bf16 v[156:159], a[0:3], v[92:95], 0
  ds_read_b64_tr_b16 v[88:89], v11 offset:8192
  ds_read_b64_tr_b16 v[90:91], v11 offset:9216
  v_mfma_f32_16x16x32_bf16 v[160:163], a[4:7], v[92:95], 0
  s_add_u32 s77, s76, 53248
  s_and_b32 s77, s77, 0xffff
  s_add_u32 m0, s24, 53248
  s_nop 0
  buffer_load_dwordx4 v126, s[44:47], s77 offen sc1 lds
  v_lshl_add_u32 v40, v41, 1, v40
  v_mfma_f32_16x16x32_bf16 v[164:167], v[92:95], v[92:95], 0
  s_waitcnt lgkmcnt(6)
  v_bfe_u32 v42, v0, 3, 1
  v_add_u32 v40, v40, v42
  v_mfma_f32_16x16x32_bf16 v[144:147], a[12:15], v[96:99], v[144:147]
  ds_read_b64_tr_b16 v[92:93], v10 offset:12288
  ds_read_b64_tr_b16 v[94:95], v10 offset:13312
  v_mfma_f32_16x16x32_bf16 v[148:151], a[16:19], v[96:99], v[148:151]
  s_add_u32 s77, s76, 57344
  s_and_b32 s77, s77, 0xffff
  s_add_u32 m0, s24, 57344
  s_nop 0
  buffer_load_dwordx4 v126, s[44:47], s77 offen sc1 lds
  v_lshlrev_b32 v40, 7, v40
  v_mfma_f32_16x16x32_bf16 v[152:155], v[96:99], v[96:99], v[152:155]
  s_waitcnt lgkmcnt(6)
  v_bfe_u32 v42, v0, 4, 1
  v_mfma_f32_16x16x32_bf16 v[156:159], a[12:15], v[100:103], v[156:159]
  ds_read_b64_tr_b16 v[96:97], v11 offset:12288
  ds_read_b64_tr_b16 v[98:99], v11 offset:13312
  s_and_b32 s60, s56, 2
  v_mfma_f32_16x16x32_bf16 v[160:163], a[16:19], v[100:103], v[160:163]
  s_add_u32 s77, s76, 61440
  s_and_b32 s77, s77, 0xffff
  s_add_u32 m0, s24, 61440
  s_nop 0
  buffer_load_dwordx4 v126, s[44:47], s77 offen sc1 lds
  v_add_u32 v42, s60, v42
  v_mfma_f32_16x16x32_bf16 v[164:167], v[100:103], v[100:103], v[164:167]
  s_waitcnt lgkmcnt(6)
  v_xor_b32 v42, v42, v41
  v_lshl_add_u32 v40, v42, 5, v40
  v_mfma_f32_16x16x32_bf16 v[144:147], a[24:27], v[104:107], v[144:147]
  s_waitcnt vmcnt(8)
  s_barrier
  ds_read_b64_tr_b16 v[100:101], v10 offset:16384
  ds_read_b64_tr_b16 v[102:103], v10 offset:17408
  v_mfma_f32_16x16x32_bf16 v[148:151], a[28:31], v[104:107], v[148:151]
  v_and_b32 v42, 3, v0
  v_lshl_add_u32 v40, v42, 3, v40
  v_mfma_f32_16x16x32_bf16 v[152:155], v[104:107], v[104:107], v[152:155]
  s_and_b32 s60, s56, 1
  s_lshl_b32 s60, s60, 12
  s_lshl_b32 s61, s59, 13
  s_add_u32 s60, s60, s61
  s_sub_u32 s60, s60, s76
  s_and_b32 s60, s60, 0xffff
  s_and_b32 s61, s61, 0x10000
  s_add_u32 s60, s60, s61
  v_add_u32 v136, s60, v40
  v_xor_b32 v137, 64, v136
  s_waitcnt lgkmcnt(6)
  v_mfma_f32_16x16x32_bf16 v[156:159], a[24:27], v[88:91], v[156:159]
  ds_read_b64_tr_b16 v[104:105], v11 offset:16384
  ds_read_b64_tr_b16 v[106:107], v11 offset:17408
  v_mfma_f32_16x16x32_bf16 v[160:163], a[28:31], v[88:91], v[160:163]
  v_mov_b32 v143, s4
  v_permlane16_swap_b32 v84, v86
  v_mfma_f32_16x16x32_bf16 v[164:167], v[88:91], v[88:91], v[164:167]
  s_waitcnt lgkmcnt(6)
  s_add_u32 s77, s76, 0
  s_and_b32 s77, s77, 0xffff
  v_permlane16_swap_b32 v85, v87
  v_mfma_f32_16x16x32_bf16 v[144:147], a[36:39], v[92:95], v[144:147]
  s_add_u32 m0, s24, 65536
  ds_read_b64_tr_b16 v[88:89], v10 offset:20480
  ds_read_b64_tr_b16 v[90:91], v10 offset:21504
  v_mfma_f32_16x16x32_bf16 v[148:151], a[40:43], v[92:95], v[148:151]
  buffer_load_dwordx4 v43, s[44:47], s77 offen sc1 lds
  v_mfma_f32_16x16x32_bf16 v[152:155], v[92:95], v[92:95], v[152:155]
  s_waitcnt lgkmcnt(6)
  s_add_u32 s77, s76, 4096
  s_and_b32 s77, s77, 0xffff
  v_mfma_f32_16x16x32_bf16 v[156:159], a[36:39], v[96:99], v[156:159]
  s_add_u32 m0, s24, 69632
  ds_read_b64_tr_b16 v[92:93], v11 offset:20480
  ds_read_b64_tr_b16 v[94:95], v11 offset:21504
  v_mfma_f32_16x16x32_bf16 v[160:163], a[40:43], v[96:99], v[160:163]
  buffer_load_dwordx4 v43, s[44:47], s77 offen sc1 lds
  v_mfma_f32_16x16x32_bf16 v[164:167], v[96:99], v[96:99], v[164:167]
  s_waitcnt lgkmcnt(6)
  s_add_u32 s77, s76, 8192
  s_and_b32 s77, s77, 0xffff
  v_mfma_f32_16x16x32_bf16 v[144:147], a[48:51], v[100:103], v[144:147]
  s_add_u32 m0, s24, 73728
  ds_read_b64_tr_b16 v[96:97], v10 offset:24576
  ds_read_b64_tr_b16 v[98:99], v10 offset:25600
  v_mfma_f32_16x16x32_bf16 v[148:151], a[52:55], v[100:103], v[148:151]
  buffer_load_dwordx4 v43, s[44:47], s77 offen sc1 lds
  v_mfma_f32_16x16x32_bf16 v[152:155], v[100:103], v[100:103], v[152:155]
  s_waitcnt lgkmcnt(6)
  s_add_u32 s77, s76, 12288
  s_and_b32 s77, s77, 0xffff
  v_mfma_f32_16x16x32_bf16 v[156:159], a[48:51], v[104:107], v[156:159]
  s_add_u32 m0, s24, 77824
  ds_read_b64_tr_b16 v[100:101], v11 offset:24576
  ds_read_b64_tr_b16 v[102:103], v11 offset:25600
  v_mfma_f32_16x16x32_bf16 v[160:163], a[52:55], v[104:107], v[160:163]
  buffer_load_dwordx4 v43, s[44:47], s77 offen sc1 lds
  v_mfma_f32_16x16x32_bf16 v[164:167], v[104:107], v[104:107], v[164:167]
  s_waitcnt lgkmcnt(6)
  s_add_u32 s77, s76, 16384
  s_and_b32 s77, s77, 0xffff
  v_mfma_f32_16x16x32_bf16 v[144:147], a[60:63], v[88:91], v[144:147]
  s_add_u32 m0, s24, 81920
  ds_read_b64_tr_b16 v[104:105], v10 offset:28672
  ds_read_b64_tr_b16 v[106:107], v10 offset:29696
  v_mfma_f32_16x16x32_bf16 v[148:151], a[64:67], v[88:91], v[148:151]
  buffer_load_dwordx4 v43, s[44:47], s77 offen sc1 lds
  v_mfma_f32_16x16x32_bf16 v[152:155], v[88:91], v[88:91], v[152:155]
  s_waitcnt lgkmcnt(6)
  s_add_u32 s77, s76, 20480
  s_and_b32 s77, s77, 0xffff
  v_mfma_f32_16x16x32_bf16 v[156:159], a[60:63], v[92:95], v[156:159]
  s_add_u32 m0, s24, 86016
  ds_read_b64_tr_b16 v[88:89], v11 offset:28672
  ds_read_b64_tr_b16 v[90:91], v11 offset:29696
  v_mfma_f32_16x16x32_bf16 v[160:163], a[64:67], v[92:95], v[160:163]
  buffer_load_dwordx4 v43, s[44:47], s77 offen sc1 lds
  v_mfma_f32_16x16x32_bf16 v[164:167], v[92:95], v[92:95], v[164:167]
  s_waitcnt lgkmcnt(6)
  s_add_u32 s77, s76, 24576
  s_and_b32 s77, s77, 0xffff
  v_mfma_f32_16x16x32_bf16 v[144:147], a[72:75], v[96:99], v[144:147]
  s_waitcnt vmcnt(10)
  s_barrier
  s_add_u32 m0, s24, 90112
  ds_read_b64_tr_b16 v[92:93], v10 offset:32768
  ds_read_b64_tr_b16 v[94:95], v10 offset:33792
  v_mfma_f32_16x16x32_bf16 v[148:151], a[76:79], v[96:99], v[148:151]
  buffer_load_dwordx4 v43, s[44:47], s77 offen sc1 lds
  v_mfma_f32_16x16x32_bf16 v[152:155], v[96:99], v[96:99], v[152:155]
  s_waitcnt lgkmcnt(6)
  s_add_u32 s77, s76, 28672
  s_and_b32 s77, s77, 0xffff
  v_mfma_f32_16x16x32_bf16 v[156:159], a[72:75], v[100:103], v[156:159]
  s_add_u32 m0, s24, 94208
  ds_read_b64_tr_b16 v[96:97], v11 offset:32768
  ds_read_b64_tr_b16 v[98:99], v11 offset:33792
  v_mfma_f32_16x16x32_bf16 v[160:163], a[76:79], v[100:103], v[160:163]
  buffer_load_dwordx4 v43, s[44:47], s77 offen sc1 lds
  v_mfma_f32_16x16x32_bf16 v[164:167], v[100:103], v[100:103], v[164:167]
  s_waitcnt lgkmcnt(6)
  s_add_u32 s77, s76, 32768
  s_and_b32 s77, s77, 0xffff
  v_mfma_f32_16x16x32_bf16 v[144:147], a[84:87], v[104:107], v[144:147]
  s_add_u32 m0, s24, 98304
  ds_read_b64_tr_b16 v[100:101], v10 offset:36864
  ds_read_b64_tr_b16 v[102:103], v10 offset:37888
  v_mfma_f32_16x16x32_bf16 v[148:151], a[88:91], v[104:107], v[148:151]
  buffer_load_dwordx4 v43, s[44:47], s77 offen sc1 lds
  v_mfma_f32_16x16x32_bf16 v[152:155], v[104:107], v[104:107], v[152:155]
  s_waitcnt lgkmcnt(6)
  s_add_u32 s77, s76, 36864
  s_and_b32 s77, s77, 0xffff
  v_mfma_f32_16x16x32_bf16 v[156:159], a[84:87], v[88:91], v[156:159]
  s_add_u32 m0, s24, 102400
  ds_read_b64_tr_b16 v[104:105], v11 offset:36864
  ds_read_b64_tr_b16 v[106:107], v11 offset:37888
  v_mfma_f32_16x16x32_bf16 v[160:163], a[88:91], v[88:91], v[160:163]
  buffer_load_dwordx4 v43, s[44:47], s77 offen sc1 lds
  v_mfma_f32_16x16x32_bf16 v[164:167], v[88:91], v[88:91], v[164:167]
  s_waitcnt lgkmcnt(6)
  s_add_u32 s77, s76, 40960
  s_and_b32 s77, s77, 0xffff
  v_mfma_f32_16x16x32_bf16 v[144:147], a[96:99], v[92:95], v[144:147]
  s_add_u32 m0, s24, 106496
  ds_read_b64_tr_b16 v[88:89], v10 offset:40960
  ds_read_b64_tr_b16 v[90:91], v10 offset:41984
  v_mfma_f32_16x16x32_bf16 v[148:151], a[100:103], v[92:95], v[148:151]
  buffer_load_dwordx4 v43, s[44:47], s77 offen sc1 lds
  v_mfma_f32_16x16x32_bf16 v[152:155], v[92:95], v[92:95], v[152:155]
  s_waitcnt lgkmcnt(6)
  s_add_u32 s77, s76, 45056
  s_and_b32 s77, s77, 0xffff
  v_mfma_f32_16x16x32_bf16 v[156:159], a[96:99], v[96:99], v[156:159]
  s_add_u32 m0, s24, 110592
  ds_read_b64_tr_b16 v[92:93], v11 offset:40960
  ds_read_b64_tr_b16 v[94:95], v11 offset:41984
  v_mfma_f32_16x16x32_bf16 v[160:163], a[100:103], v[96:99], v[160:163]
  buffer_load_dwordx4 v43, s[44:47], s77 offen sc1 lds
  v_mfma_f32_16x16x32_bf16 v[164:167], v[96:99], v[96:99], v[164:167]
  s_waitcnt lgkmcnt(6)
  s_add_u32 s77, s76, 49152
  s_and_b32 s77, s77, 0xffff
  v_mfma_f32_16x16x32_bf16 v[144:147], a[108:111], v[100:103], v[144:147]
  s_add_u32 m0, s24, 114688
  ds_read_b64_tr_b16 v[96:97], v10 offset:45056
  ds_read_b64_tr_b16 v[98:99], v10 offset:46080
  v_mfma_f32_16x16x32_bf16 v[148:151], a[112:115], v[100:103], v[148:151]
  buffer_load_dwordx4 v43, s[44:47], s77 offen sc1 lds
  v_mfma_f32_16x16x32_bf16 v[152:155], v[100:103], v[100:103], v[152:155]
  s_waitcnt lgkmcnt(6)
  s_add_u32 s77, s76, 53248
  s_and_b32 s77, s77, 0xffff
  v_mfma_f32_16x16x32_bf16 v[156:159], a[108:111], v[104:107], v[156:159]
  s_add_u32 m0, s24, 118784
  ds_read_b64_tr_b16 v[100:101], v11 offset:45056
  ds_read_b64_tr_b16 v[102:103], v11 offset:46080
  v_mfma_f32_16x16x32_bf16 v[160:163], a[112:115], v[104:107], v[160:163]
  buffer_load_dwordx4 v43, s[44:47], s77 offen sc1 lds
  v_mfma_f32_16x16x32_bf16 v[164:167], v[104:107], v[104:107], v[164:167]
  s_waitcnt lgkmcnt(6)
  s_add_u32 s77, s76, 57344
  s_and_b32 s77, s77, 0xffff
  v_mfma_f32_16x16x32_bf16 v[144:147], a[120:123], v[88:91], v[144:147]
  s_waitcnt vmcnt(14)
  s_barrier
  s_add_u32 m0, s24, 122880
  ds_read_b64_tr_b16 v[104:105], v10 offset:49152
  ds_read_b64_tr_b16 v[106:107], v10 offset:50176
  v_mfma_f32_16x16x32_bf16 v[148:151], a[124:127], v[88:91], v[148:151]
  buffer_load_dwordx4 v43, s[44:47], s77 offen sc1 lds
  v_mfma_f32_16x16x32_bf16 v[152:155], v[88:91], v[88:91], v[152:155]
  s_waitcnt lgkmcnt(6)
  s_add_u32 s77, s76, 61440
  s_and_b32 s77, s77, 0xffff
  v_mfma_f32_16x16x32_bf16 v[156:159], a[120:123], v[92:95], v[156:159]
  s_add_u32 m0, s24, 126976
  ds_read_b64_tr_b16 v[88:89], v11 offset:49152
  ds_read_b64_tr_b16 v[90:91], v11 offset:50176
  v_mfma_f32_16x16x32_bf16 v[160:163], a[124:127], v[92:95], v[160:163]
  buffer_load_dwordx4 v43, s[44:47], s77 offen sc1 lds
  v_mfma_f32_16x16x32_bf16 v[164:167], v[92:95], v[92:95], v[164:167]
  s_waitcnt lgkmcnt(6)
  v_mfma_f32_16x16x32_bf16 v[144:147], a[132:135], v[96:99], v[144:147]
  ds_read_b64_tr_b16 v[92:93], v10 offset:53248
  ds_read_b64_tr_b16 v[94:95], v10 offset:54272
  v_mfma_f32_16x16x32_bf16 v[148:151], a[136:139], v[96:99], v[148:151]
  s_mov_b32 exec_hi, 0x1fff
  buffer_load_dword a255, v127, s[44:47], 0 offen sc1
  s_mov_b64 exec, -1
  v_mfma_f32_16x16x32_bf16 v[152:155], v[96:99], v[96:99], v[152:155]
  s_waitcnt lgkmcnt(6)
  s_add_u32 m0, s24, 135168
  v_mfma_f32_16x16x32_bf16 v[156:159], a[132:135], v[100:103], v[156:159]
  s_add_u32 s77, s7, 0
  ds_read_b64_tr_b16 v[96:97], v11 offset:53248
  ds_read_b64_tr_b16 v[98:99], v11 offset:54272
  v_mfma_f32_16x16x32_bf16 v[160:163], a[136:139], v[100:103], v[160:163]
  buffer_load_dwordx4 v124, s[36:39], s77 offen  lds
  v_mfma_f32_16x16x32_bf16 v[164:167], v[100:103], v[100:103], v[164:167]
  s_waitcnt lgkmcnt(6)
  v_mfma_f32_16x16x32_bf16 v[144:147], a[144:147], v[104:107], v[144:147]
  ds_read_b64_tr_b16 v[100:101], v10 offset:57344
  ds_read_b64_tr_b16 v[102:103], v10 offset:58368
  v_mfma_f32_16x16x32_bf16 v[148:151], a[148:151], v[104:107], v[148:151]
  v_mfma_f32_16x16x32_bf16 v[152:155], v[104:107], v[104:107], v[152:155]
  s_waitcnt lgkmcnt(6)
  s_add_u32 m0, s24, 139264
  v_mfma_f32_16x16x32_bf16 v[156:159], a[144:147], v[88:91], v[156:159]
  s_add_u32 s77, s7, 16384
  ds_read_b64_tr_b16 v[104:105], v11 offset:57344
  ds_read_b64_tr_b16 v[106:107], v11 offset:58368
  v_mfma_f32_16x16x32_bf16 v[160:163], a[148:151], v[88:91], v[160:163]
  buffer_load_dwordx4 v124, s[36:39], s77 offen  lds
  v_mfma_f32_16x16x32_bf16 v[164:167], v[88:91], v[88:91], v[164:167]
  s_waitcnt lgkmcnt(6)
  v_mfma_f32_16x16x32_bf16 v[144:147], a[156:159], v[92:95], v[144:147]
  ds_read_b64_tr_b16 v[88:89], v10 offset:61440
  ds_read_b64_tr_b16 v[90:91], v10 offset:62464
  v_mfma_f32_16x16x32_bf16 v[148:151], a[160:163], v[92:95], v[148:151]
  v_mfma_f32_16x16x32_bf16 v[152:155], v[92:95], v[92:95], v[152:155]
  s_waitcnt lgkmcnt(6)
  s_add_u32 m0, s24, 143360
  v_mfma_f32_16x16x32_bf16 v[156:159], a[156:159], v[96:99], v[156:159]
  s_add_u32 s77, s7, 32768
  ds_read_b64_tr_b16 v[92:93], v11 offset:61440
  ds_read_b64_tr_b16 v[94:95], v11 offset:62464
  v_mfma_f32_16x16x32_bf16 v[160:163], a[160:163], v[96:99], v[160:163]
  buffer_load_dwordx4 v124, s[36:39], s77 offen  lds
  v_mfma_f32_16x16x32_bf16 v[164:167], v[96:99], v[96:99], v[164:167]
  s_waitcnt lgkmcnt(6)
  v_mfma_f32_16x16x32_bf16 v[144:147], a[168:171], v[100:103], v[144:147]
  ds_read_b64_tr_b16 v[96:97], v139 offset:0
  ds_read_b64_tr_b16 v[98:99], v139 offset:1024
  v_mfma_f32_16x16x32_bf16 v[148:151], a[172:175], v[100:103], v[148:151]
  v_mfma_f32_16x16x32_bf16 v[152:155], v[100:103], v[100:103], v[152:155]
  s_waitcnt lgkmcnt(6)
  s_add_u32 m0, s24, 147456
  v_mfma_f32_16x16x32_bf16 v[156:159], a[168:171], v[104:107], v[156:159]
  s_add_u32 s77, s7, 49152
  ds_read_b64_tr_b16 v[100:101], v139 offset:4096
  ds_read_b64_tr_b16 v[102:103], v139 offset:5120
  v_mfma_f32_16x16x32_bf16 v[160:163], a[172:175], v[104:107], v[160:163]
  buffer_load_dwordx4 v124, s[36:39], s77 offen  lds
  v_mfma_f32_16x16x32_bf16 v[164:167], v[104:107], v[104:107], v[164:167]
  s_waitcnt lgkmcnt(6)
  v_mfma_f32_16x16x32_bf16 v[144:147], a[180:183], v[88:91], v[144:147]
  ds_read_b64_tr_b16 v[104:105], v139 offset:8192
  ds_read_b64_tr_b16 v[106:107], v139 offset:9216
  v_mfma_f32_16x16x32_bf16 v[148:151], a[184:187], v[88:91], v[148:151]
  v_mfma_f32_16x16x32_bf16 v[152:155], v[88:91], v[88:91], v[152:155]
  s_waitcnt lgkmcnt(6)
  s_add_u32 m0, s24, 151552
  v_mfma_f32_16x16x32_bf16 v[156:159], a[180:183], v[92:95], v[156:159]
  s_add_u32 s77, s7, 65536
  ds_read_b64_tr_b16 v[88:89], v139 offset:12288
  ds_read_b64_tr_b16 v[90:91], v139 offset:13312
  v_mfma_f32_16x16x32_bf16 v[160:163], a[184:187], v[92:95], v[160:163]
  buffer_load_dwordx4 v124, s[36:39], s77 offen  lds
  v_mfma_f32_16x16x32_bf16 v[164:167], v[92:95], v[92:95], v[164:167]
  s_waitcnt lgkmcnt(6)
  v_mfma_f32_16x16x32_bf16 v[168:171], a[0:3], v[96:99], 0
  ds_read_b64_tr_b16 v[92:93], v139 offset:16384
  ds_read_b64_tr_b16 v[94:95], v139 offset:17408
  v_mfma_f32_16x16x32_bf16 v[172:175], a[4:7], v[96:99], 0
  v_mfma_f32_16x16x32_bf16 v[176:179], v[96:99], v[96:99], 0
  s_waitcnt lgkmcnt(6)
  s_add_u32 m0, s24, 155648
  v_mfma_f32_16x16x32_bf16 v[168:171], a[12:15], v[100:103], v[168:171]
  s_add_u32 s77, s74, 81920
  ds_read_b64_tr_b16 v[96:97], v139 offset:20480
  ds_read_b64_tr_b16 v[98:99], v139 offset:21504
  v_mfma_f32_16x16x32_bf16 v[172:175], a[16:19], v[100:103], v[172:175]
  buffer_load_dwordx4 v124, s[36:39], s77 offen  lds
  ds_bpermute_b32 v120, v15, v146
  v_mfma_f32_16x16x32_bf16 v[176:179], v[100:103], v[100:103], v[176:179]
  s_waitcnt lgkmcnt(7)
  ds_bpermute_b32 v20, v15, v158
  v_cndmask_b32 v116, v152, v153, s[72:73]
  v_mfma_f32_16x16x32_bf16 v[168:171], a[24:27], v[104:107], v[168:171]
  ds_read_b64_tr_b16 v[100:101], v139 offset:24576
  ds_read_b64_tr_b16 v[102:103], v139 offset:25600
  v_mfma_f32_16x16x32_bf16 v[172:175], a[28:31], v[104:107], v[172:175]
  v_cndmask_b32 v117, v154, v155, s[72:73]
  v_cndmask_b32 v116, v116, v117, s[78:79]
  v_mfma_f32_16x16x32_bf16 v[176:179], v[104:107], v[104:107], v[176:179]
  s_waitcnt lgkmcnt(3)
  s_add_u32 m0, s24, 159744
  v_mul_f32 v116, 0x3b000000, v116
  v_mul_f32 v120, 0xbb000000, v120
  v_mfma_f32_16x16x32_bf16 v[168:171], a[36:39], v[88:91], v[168:171]
  s_add_u32 s77, s7, 96256
  ds_read_b64_tr_b16 v[104:105], v139 offset:28672
  ds_read_b64_tr_b16 v[106:107], v139 offset:29696
  v_mfma_f32_16x16x32_bf16 v[172:175], a[40:43], v[88:91], v[172:175]
  buffer_load_dwordx4 v124, s[36:39], s77 offen  lds
  v_fma_f32 v116, -v120, v120, v116
  v_mfma_f32_16x16x32_bf16 v[176:179], v[88:91], v[88:91], v[176:179]
  v_max_f32 v116, 0, v116
  v_add_f32 v116, 0x3727c5ac, v116
  v_mfma_f32_16x16x32_bf16 v[168:171], a[48:51], v[92:95], v[168:171]
  ds_read_b64_tr_b16 v[88:89], v139 offset:32768
  ds_read_b64_tr_b16 v[90:91], v139 offset:33792
  v_mfma_f32_16x16x32_bf16 v[172:175], a[52:55], v[92:95], v[172:175]
  v_rsq_f32 v121, v116
  v_mfma_f32_16x16x32_bf16 v[176:179], v[92:95], v[92:95], v[176:179]
  v_add_u32 v123, 1, v143
  v_mul_f32 v122, v116, v121
  v_mfma_f32_16x16x32_bf16 v[168:171], a[60:63], v[96:99], v[168:171]
  ds_read_b64_tr_b16 v[92:93], v139 offset:36864
  ds_read_b64_tr_b16 v[94:95], v139 offset:37888
  v_mfma_f32_16x16x32_bf16 v[172:175], a[64:67], v[96:99], v[172:175]
  v_mul_f32 v121, 0xbfb8aa3b, v121
  v_mfma_f32_16x16x32_bf16 v[176:179], v[96:99], v[96:99], v[176:179]
  s_waitcnt lgkmcnt(6)
  ds_write_b128 v141, v[120:123] offset:0
  v_cndmask_b32 v16, v164, v165, s[72:73]
  v_mfma_f32_16x16x32_bf16 v[168:171], a[72:75], v[100:103], v[168:171]
  ds_read_b64_tr_b16 v[96:97], v139 offset:40960
  ds_read_b64_tr_b16 v[98:99], v139 offset:41984
  v_mfma_f32_16x16x32_bf16 v[172:175], a[76:79], v[100:103], v[172:175]
  v_cndmask_b32 v17, v166, v167, s[72:73]
  v_cndmask_b32 v16, v16, v17, s[78:79]
  v_mfma_f32_16x16x32_bf16 v[176:179], v[100:103], v[100:103], v[176:179]
  s_waitcnt lgkmcnt(7)
  v_mul_f32 v16, 0x3b000000, v16
  v_mul_f32 v20, 0xbb000000, v20
  v_mfma_f32_16x16x32_bf16 v[168:171], a[84:87], v[104:107], v[168:171]
  ds_read_b64_tr_b16 v[100:101], v139 offset:45056
  ds_read_b64_tr_b16 v[102:103], v139 offset:46080
  v_mfma_f32_16x16x32_bf16 v[172:175], a[88:91], v[104:107], v[172:175]
  v_fma_f32 v16, -v20, v20, v16
  v_max_f32 v16, 0, v16
  v_mfma_f32_16x16x32_bf16 v[176:179], v[104:107], v[104:107], v[176:179]
  s_waitcnt lgkmcnt(7)
  v_add_f32 v16, 0x3727c5ac, v16
  v_mfma_f32_16x16x32_bf16 v[168:171], a[96:99], v[88:91], v[168:171]
  ds_read_b64_tr_b16 v[104:105], v139 offset:49152
  ds_read_b64_tr_b16 v[106:107], v139 offset:50176
  v_mfma_f32_16x16x32_bf16 v[172:175], a[100:103], v[88:91], v[172:175]
  v_rsq_f32 v21, v16
  v_mfma_f32_16x16x32_bf16 v[176:179], v[88:91], v[88:91], v[176:179]
  s_waitcnt lgkmcnt(7)
  v_add_u32 v23, 2, v143
  v_mul_f32 v22, v16, v21
  v_mfma_f32_16x16x32_bf16 v[168:171], a[108:111], v[92:95], v[168:171]
  ds_read_b64_tr_b16 v[88:89], v139 offset:53248
  ds_read_b64_tr_b16 v[90:91], v139 offset:54272
  v_mfma_f32_16x16x32_bf16 v[172:175], a[112:115], v[92:95], v[172:175]
  v_mul_f32 v21, 0xbfb8aa3b, v21
  v_mfma_f32_16x16x32_bf16 v[176:179], v[92:95], v[92:95], v[176:179]
  s_waitcnt lgkmcnt(6)
  ds_write_b128 v141, v[20:23] offset:256
  ds_read_b128 v[108:111], v12 offset:0
  v_mfma_f32_16x16x32_bf16 v[168:171], a[120:123], v[96:99], v[168:171]
  ds_read_b64_tr_b16 v[92:93], v139 offset:57344
  ds_read_b64_tr_b16 v[94:95], v139 offset:58368
  v_mfma_f32_16x16x32_bf16 v[172:175], a[124:127], v[96:99], v[172:175]
  s_waitcnt lgkmcnt(2)
  v_fmac_f32 v144, v108, v76
  v_fmac_f32 v145, v108, v77
  v_mfma_f32_16x16x32_bf16 v[176:179], v[96:99], v[96:99], v[176:179]
  v_fmac_f32 v146, v108, v78
  v_fmac_f32 v147, v108, v79
  v_mfma_f32_16x16x32_bf16 v[168:171], a[132:135], v[100:103], v[168:171]
  ds_read_b64_tr_b16 v[96:97], v139 offset:61440
  ds_read_b64_tr_b16 v[98:99], v139 offset:62464
  v_mfma_f32_16x16x32_bf16 v[172:175], a[136:139], v[100:103], v[172:175]
  v_mul_f32 v144, v144, v109
  v_mul_f32 v145, v145, v109
  v_mfma_f32_16x16x32_bf16 v[176:179], v[100:103], v[100:103], v[176:179]
  v_mul_f32 v146, v146, v109
  v_mul_f32 v147, v147, v109
  v_mfma_f32_16x16x32_bf16 v[168:171], a[144:147], v[104:107], v[168:171]
  ds_read_b64_tr_b16 v[100:101], v140 offset:0
  ds_read_b64_tr_b16 v[102:103], v140 offset:1024
  v_mfma_f32_16x16x32_bf16 v[172:175], a[148:151], v[104:107], v[172:175]
  v_exp_f32 v144, v144
  v_mfma_f32_16x16x32_bf16 v[176:179], v[104:107], v[104:107], v[176:179]
  v_exp_f32 v145, v145
  v_mfma_f32_16x16x32_bf16 v[168:171], a[156:159], v[88:91], v[168:171]
  ds_read_b64_tr_b16 v[104:105], v140 offset:4096
  ds_read_b64_tr_b16 v[106:107], v140 offset:5120
  v_mfma_f32_16x16x32_bf16 v[172:175], a[160:163], v[88:91], v[172:175]
  v_exp_f32 v146, v146
  v_mfma_f32_16x16x32_bf16 v[176:179], v[88:91], v[88:91], v[176:179]
  s_waitcnt lgkmcnt(6)
  v_exp_f32 v147, v147
  v_mfma_f32_16x16x32_bf16 v[168:171], a[168:171], v[92:95], v[168:171]
  ds_read_b64_tr_b16 v[88:89], v140 offset:8192
  ds_read_b64_tr_b16 v[90:91], v140 offset:9216
  v_mfma_f32_16x16x32_bf16 v[172:175], a[172:175], v[92:95], v[172:175]
  ds_read_b128 v[112:115], v12 offset:256
  v_fmac_f32 v148, v108, v80
  v_mfma_f32_16x16x32_bf16 v[176:179], v[92:95], v[92:95], v[176:179]
  s_waitcnt lgkmcnt(7)
  v_fmac_f32 v149, v108, v81
  v_fmac_f32 v150, v108, v82
  v_mfma_f32_16x16x32_bf16 v[168:171], a[180:183], v[96:99], v[168:171]
  ds_read_b64_tr_b16 v[92:93], v140 offset:12288
  ds_read_b64_tr_b16 v[94:95], v140 offset:13312
  v_mfma_f32_16x16x32_bf16 v[172:175], a[184:187], v[96:99], v[172:175]
  v_fmac_f32 v151, v108, v83
  v_fma_f32 v144, v144, v110, v110
  v_mfma_f32_16x16x32_bf16 v[176:179], v[96:99], v[96:99], v[176:179]
  s_waitcnt lgkmcnt(7)
  v_fma_f32 v145, v145, v110, v110
  v_fma_f32 v146, v146, v110, v110
  v_mfma_f32_16x16x32_bf16 v[180:183], a[0:3], v[100:103], 0
  ds_read_b64_tr_b16 v[96:97], v140 offset:16384
  ds_read_b64_tr_b16 v[98:99], v140 offset:17408
  v_mfma_f32_16x16x32_bf16 v[184:187], a[4:7], v[100:103], 0
  v_fma_f32 v147, v147, v110, v110
  v_mfma_f32_16x16x32_bf16 v[188:191], v[100:103], v[100:103], 0
  s_waitcnt lgkmcnt(7)
  v_rcp_f32 v144, v144
  v_mfma_f32_16x16x32_bf16 v[180:183], a[12:15], v[104:107], v[180:183]
  ds_read_b64_tr_b16 v[100:101], v140 offset:20480
  ds_read_b64_tr_b16 v[102:103], v140 offset:21504
  v_mfma_f32_16x16x32_bf16 v[184:187], a[16:19], v[104:107], v[184:187]
  ds_bpermute_b32 v120, v15, v170
  v_cndmask_b32 v116, v176, v177, s[72:73]
  v_mfma_f32_16x16x32_bf16 v[188:191], v[104:107], v[104:107], v[188:191]
  s_waitcnt lgkmcnt(8)
  v_cndmask_b32 v117, v178, v179, s[72:73]
  v_cndmask_b32 v116, v116, v117, s[78:79]
  v_mfma_f32_16x16x32_bf16 v[180:183], a[24:27], v[88:91], v[180:183]
  ds_read_b64_tr_b16 v[104:105], v140 offset:24576
  ds_read_b64_tr_b16 v[106:107], v140 offset:25600
  v_mfma_f32_16x16x32_bf16 v[184:187], a[28:31], v[88:91], v[184:187]
  v_mul_f32 v116, 0x3b000000, v116
  v_mfma_f32_16x16x32_bf16 v[188:191], v[88:91], v[88:91], v[188:191]
  s_waitcnt lgkmcnt(2)
  v_mul_f32 v120, 0xbb000000, v120
  v_fma_f32 v116, -v120, v120, v116
  v_mfma_f32_16x16x32_bf16 v[180:183], a[36:39], v[92:95], v[180:183]
  ds_read_b64_tr_b16 v[88:89], v140 offset:28672
  ds_read_b64_tr_b16 v[90:91], v140 offset:29696
  v_mfma_f32_16x16x32_bf16 v[184:187], a[40:43], v[92:95], v[184:187]
  v_max_f32 v116, 0, v116
  v_add_f32 v116, 0x3727c5ac, v116
  v_mfma_f32_16x16x32_bf16 v[188:191], v[92:95], v[92:95], v[188:191]
  v_rsq_f32 v121, v116
  v_mfma_f32_16x16x32_bf16 v[180:183], a[48:51], v[96:99], v[180:183]
  ds_read_b64_tr_b16 v[92:93], v140 offset:32768
  ds_read_b64_tr_b16 v[94:95], v140 offset:33792
  v_mfma_f32_16x16x32_bf16 v[184:187], a[52:55], v[96:99], v[184:187]
  v_add_u32 v123, 3, v143
  v_mul_f32 v122, v116, v121
  v_mfma_f32_16x16x32_bf16 v[188:191], v[96:99], v[96:99], v[188:191]
  v_mul_f32 v121, 0xbfb8aa3b, v121
  v_mfma_f32_16x16x32_bf16 v[180:183], a[60:63], v[100:103], v[180:183]
  ds_read_b64_tr_b16 v[96:97], v140 offset:36864
  ds_read_b64_tr_b16 v[98:99], v140 offset:37888
  v_mfma_f32_16x16x32_bf16 v[184:187], a[64:67], v[100:103], v[184:187]
  ds_write_b128 v141, v[120:123] offset:512
  v_mfma_f32_16x16x32_bf16 v[188:191], v[100:103], v[100:103], v[188:191]
  s_waitcnt lgkmcnt(7)
  v_rcp_f32 v145, v145
  v_mfma_f32_16x16x32_bf16 v[180:183], a[72:75], v[104:107], v[180:183]
  ds_read_b64_tr_b16 v[100:101], v140 offset:40960
  ds_read_b64_tr_b16 v[102:103], v140 offset:41984
  v_mfma_f32_16x16x32_bf16 v[184:187], a[76:79], v[104:107], v[184:187]
  v_rcp_f32 v146, v146
  v_mfma_f32_16x16x32_bf16 v[188:191], v[104:107], v[104:107], v[188:191]
  s_waitcnt lgkmcnt(7)
  v_rcp_f32 v147, v147
  v_mfma_f32_16x16x32_bf16 v[180:183], a[84:87], v[88:91], v[180:183]
  ds_read_b64_tr_b16 v[104:105], v140 offset:45056
  ds_read_b64_tr_b16 v[106:107], v140 offset:46080
  s_add_u32 s69, s68, 0
  v_mfma_f32_16x16x32_bf16 v[184:187], a[88:91], v[88:91], v[184:187]
  v_mul_f32 v144, v144, v148
  v_mul_f32 v145, v145, v149
  v_mfma_f32_16x16x32_bf16 v[188:191], v[88:91], v[88:91], v[188:191]
  s_waitcnt lgkmcnt(7)
  v_mul_f32 v146, v146, v150
  v_mul_f32 v147, v147, v151
  v_mfma_f32_16x16x32_bf16 v[180:183], a[96:99], v[92:95], v[180:183]
  ds_read_b64_tr_b16 v[88:89], v140 offset:49152
  ds_read_b64_tr_b16 v[90:91], v140 offset:50176
  v_mfma_f32_16x16x32_bf16 v[184:187], a[100:103], v[92:95], v[184:187]
  v_cvt_pk_bf16_f32 v148, v144, v145
  v_cvt_pk_bf16_f32 v149, v146, v147
  v_mfma_f32_16x16x32_bf16 v[188:191], v[92:95], v[92:95], v[188:191]
  s_waitcnt lgkmcnt(7)
  v_cndmask_b32 v149, v149, 0, s[70:71]
  v_mfma_f32_16x16x32_bf16 v[180:183], a[108:111], v[96:99], v[180:183]
  ds_read_b64_tr_b16 v[92:93], v140 offset:53248
  ds_read_b64_tr_b16 v[94:95], v140 offset:54272
  v_mfma_f32_16x16x32_bf16 v[184:187], a[112:115], v[96:99], v[184:187]
  buffer_store_dwordx2 v[148:149], v13, s[44:47], s69 offen
  v_fmac_f32 v156, v112, v76
  v_mfma_f32_16x16x32_bf16 v[188:191], v[96:99], v[96:99], v[188:191]
  s_waitcnt lgkmcnt(6)
  v_fmac_f32 v157, v112, v77
  v_fmac_f32 v158, v112, v78
  v_mfma_f32_16x16x32_bf16 v[180:183], a[120:123], v[100:103], v[180:183]
  ds_read_b64_tr_b16 v[96:97], v140 offset:57344
  ds_read_b64_tr_b16 v[98:99], v140 offset:58368
  v_mfma_f32_16x16x32_bf16 v[184:187], a[124:127], v[100:103], v[184:187]
  v_fmac_f32 v159, v112, v79
  v_mul_f32 v156, v156, v113
  v_mfma_f32_16x16x32_bf16 v[188:191], v[100:103], v[100:103], v[188:191]
  s_waitcnt lgkmcnt(6)
  v_mul_f32 v157, v157, v113
  v_mul_f32 v158, v158, v113
  v_mfma_f32_16x16x32_bf16 v[180:183], a[132:135], v[104:107], v[180:183]
  ds_read_b64_tr_b16 v[100:101], v140 offset:61440
  ds_read_b64_tr_b16 v[102:103], v140 offset:62464
  v_mfma_f32_16x16x32_bf16 v[184:187], a[136:139], v[104:107], v[184:187]
  v_mul_f32 v159, v159, v113
  v_mfma_f32_16x16x32_bf16 v[188:191], v[104:107], v[104:107], v[188:191]
  s_waitcnt lgkmcnt(6)
  v_add_u32 v10, 65536, v10
  v_mfma_f32_16x16x32_bf16 v[180:183], a[144:147], v[88:91], v[180:183]
  s_waitcnt vmcnt(1)
  s_barrier
  ds_read_b64_tr_b16 v[104:105], v10 offset:0
  ds_read_b64_tr_b16 v[106:107], v10 offset:1024
  v_mfma_f32_16x16x32_bf16 v[184:187], a[148:151], v[88:91], v[184:187]
  v_exp_f32 v156, v156
  v_mfma_f32_16x16x32_bf16 v[188:191], v[88:91], v[88:91], v[188:191]
  s_waitcnt lgkmcnt(6)
  v_exp_f32 v157, v157
  v_mfma_f32_16x16x32_bf16 v[180:183], a[156:159], v[92:95], v[180:183]
  ds_read_b64_tr_b16 v[88:89], v10 offset:4096
  ds_read_b64_tr_b16 v[90:91], v10 offset:5120
  v_mfma_f32_16x16x32_bf16 v[184:187], a[160:163], v[92:95], v[184:187]
  v_exp_f32 v158, v158
  v_mfma_f32_16x16x32_bf16 v[188:191], v[92:95], v[92:95], v[188:191]
  s_waitcnt lgkmcnt(6)
  v_exp_f32 v159, v159
  v_mfma_f32_16x16x32_bf16 v[180:183], a[168:171], v[96:99], v[180:183]
  ds_read_b64_tr_b16 v[92:93], v10 offset:8192
  ds_read_b64_tr_b16 v[94:95], v10 offset:9216
  v_mfma_f32_16x16x32_bf16 v[184:187], a[172:175], v[96:99], v[184:187]
  ds_read_b128 v[108:111], v12 offset:512
  v_fmac_f32 v160, v112, v80
  v_mfma_f32_16x16x32_bf16 v[188:191], v[96:99], v[96:99], v[188:191]
  s_waitcnt lgkmcnt(7)
  v_fmac_f32 v161, v112, v81
  v_add_u32 v138, 135168, v125
  v_mfma_f32_16x16x32_bf16 v[180:183], a[180:183], v[100:103], v[180:183]
  ds_read_b64_tr_b16 v[96:97], v10 offset:12288
  ds_read_b64_tr_b16 v[98:99], v10 offset:13312
  v_mfma_f32_16x16x32_bf16 v[184:187], a[184:187], v[100:103], v[184:187]
  v_fmac_f32 v162, v112, v82
  v_fmac_f32 v163, v112, v83
  v_mfma_f32_16x16x32_bf16 v[188:191], v[100:103], v[100:103], v[188:191]
  s_waitcnt lgkmcnt(7)
  v_fma_f32 v156, v156, v114, v114
  v_fma_f32 v157, v157, v114, v114
  v_mfma_f32_16x16x32_bf16 v[192:195], a[0:3], v[104:107], 0
  ds_read_b64_tr_b16 v[100:101], v10 offset:16384
  ds_read_b64_tr_b16 v[102:103], v10 offset:17408
  v_mfma_f32_16x16x32_bf16 v[196:199], a[4:7], v[104:107], 0
  ds_read_b64_tr_b16 v[128:129], v136 offset:0
  v_fma_f32 v158, v158, v114, v114
  v_mfma_f32_16x16x32_bf16 v[200:203], v[104:107], v[104:107], 0
  s_waitcnt lgkmcnt(8)
  ds_read_b64_tr_b16 v[130:131], v137 offset:512
  v_fma_f32 v159, v159, v114, v114
  v_mfma_f32_16x16x32_bf16 v[192:195], a[12:15], v[88:91], v[192:195]
  ds_read_b64_tr_b16 v[104:105], v10 offset:20480
  ds_read_b64_tr_b16 v[106:107], v10 offset:21504
  v_mfma_f32_16x16x32_bf16 v[196:199], a[16:19], v[88:91], v[196:199]
  ds_read_b64_tr_b16 v[132:133], v136 offset:2048
  ds_bpermute_b32 v120, v15, v182
  v_mfma_f32_16x16x32_bf16 v[200:203], v[88:91], v[88:91], v[200:203]
  s_waitcnt lgkmcnt(11)
  ds_read_b64_tr_b16 v[134:135], v137 offset:2560
  v_cndmask_b32 v116, v188, v189, s[72:73]
  v_mfma_f32_16x16x32_bf16 v[192:195], a[24:27], v[92:95], v[192:195]
  ds_read_b64_tr_b16 v[88:89], v10 offset:24576
  ds_read_b64_tr_b16 v[90:91], v10 offset:25600
  v_mfma_f32_16x16x32_bf16 v[196:199], a[28:31], v[92:95], v[196:199]
  ds_read_b64_tr_b16 a[192:193], v138 offset:0
  v_cndmask_b32 v117, v190, v191, s[72:73]
  v_mfma_f32_16x16x32_bf16 v[200:203], v[92:95], v[92:95], v[200:203]
  s_waitcnt lgkmcnt(12)
  ds_read_b64_tr_b16 a[194:195], v138 offset:512
  v_cndmask_b32 v116, v116, v117, s[78:79]
  v_mfma_f32_16x16x32_bf16 v[192:195], a[36:39], v[96:99], v[192:195]
  ds_read_b64_tr_b16 v[92:93], v10 offset:28672
  ds_read_b64_tr_b16 v[94:95], v10 offset:29696
  v_mfma_f32_16x16x32_bf16 v[196:199], a[40:43], v[96:99], v[196:199]
  ds_read_b64_tr_b16 a[196:197], v138 offset:4096
  v_mul_f32 v116, 0x3b000000, v116
  v_mfma_f32_16x16x32_bf16 v[200:203], v[96:99], v[96:99], v[200:203]
  s_waitcnt lgkmcnt(8)
  ds_read_b64_tr_b16 a[198:199], v138 offset:4608
  v_mul_f32 v120, 0xbb000000, v120
  v_mfma_f32_16x16x32_bf16 v[192:195], a[48:51], v[100:103], v[192:195]
  ds_read_b64_tr_b16 v[96:97], v10 offset:32768
  ds_read_b64_tr_b16 v[98:99], v10 offset:33792
  v_mfma_f32_16x16x32_bf16 v[196:199], a[52:55], v[100:103], v[196:199]
  ds_read_b64_tr_b16 a[200:201], v138 offset:8192
  v_fma_f32 v116, -v120, v120, v116
  v_mfma_f32_16x16x32_bf16 v[200:203], v[100:103], v[100:103], v[200:203]
  ds_read_b64_tr_b16 a[202:203], v138 offset:8704
  v_max_f32 v116, 0, v116
  v_mfma_f32_16x16x32_bf16 v[192:195], a[60:63], v[104:107], v[192:195]
  ds_read_b64_tr_b16 v[100:101], v10 offset:36864
  ds_read_b64_tr_b16 v[102:103], v10 offset:37888
  v_mfma_f32_16x16x32_bf16 v[196:199], a[64:67], v[104:107], v[196:199]
  ds_read_b64_tr_b16 a[204:205], v138 offset:12288
  v_add_f32 v116, 0x3727c5ac, v116
  v_mfma_f32_16x16x32_bf16 v[200:203], v[104:107], v[104:107], v[200:203]
  s_waitcnt lgkmcnt(13)
  ds_read_b64_tr_b16 a[206:207], v138 offset:12800
  v_mfma_f32_16x16x32_bf16 v[192:195], a[72:75], v[88:91], v[192:195]
  ds_read_b64_tr_b16 v[104:105], v10 offset:40960
  ds_read_b64_tr_b16 v[106:107], v10 offset:41984
  v_mfma_f32_16x16x32_bf16 v[196:199], a[76:79], v[88:91], v[196:199]
  ds_read_b64_tr_b16 a[208:209], v138 offset:16384
  v_mfma_f32_16x16x32_bf16 v[200:203], v[88:91], v[88:91], v[200:203]
  s_waitcnt lgkmcnt(13)
  ds_read_b64_tr_b16 a[210:211], v138 offset:16896
  v_mfma_f32_16x16x32_bf16 v[192:195], a[84:87], v[92:95], v[192:195]
  ds_read_b64_tr_b16 v[88:89], v10 offset:45056
  ds_read_b64_tr_b16 v[90:91], v10 offset:46080
  v_mfma_f32_16x16x32_bf16 v[196:199], a[88:91], v[92:95], v[196:199]
  ds_read_b64_tr_b16 a[212:213], v138 offset:20480
  v_mfma_f32_16x16x32_bf16 v[200:203], v[92:95], v[92:95], v[200:203]
  s_waitcnt lgkmcnt(13)
  ds_read_b64_tr_b16 a[214:215], v138 offset:20992
  v_mfma_f32_16x16x32_bf16 v[192:195], a[96:99], v[96:99], v[192:195]
  ds_read_b64_tr_b16 v[92:93], v10 offset:49152
  ds_read_b64_tr_b16 v[94:95], v10 offset:50176
  v_mfma_f32_16x16x32_bf16 v[196:199], a[100:103], v[96:99], v[196:199]
  ds_read_b64_tr_b16 a[216:217], v138 offset:24576
  v_mfma_f32_16x16x32_bf16 v[200:203], v[96:99], v[96:99], v[200:203]
  s_waitcnt lgkmcnt(13)
  ds_read_b64_tr_b16 a[218:219], v138 offset:25088
  v_mfma_f32_16x16x32_bf16 v[192:195], a[108:111], v[100:103], v[192:195]
  ds_read_b64_tr_b16 v[96:97], v10 offset:53248
  ds_read_b64_tr_b16 v[98:99], v10 offset:54272
  v_mfma_f32_16x16x32_bf16 v[196:199], a[112:115], v[100:103], v[196:199]
  v_rsq_f32 v121, v116
  v_mfma_f32_16x16x32_bf16 v[200:203], v[100:103], v[100:103], v[200:203]
  s_waitcnt lgkmcnt(12)
  v_add_u32 v123, 4, v143
  v_mul_f32 v122, v116, v121
  v_mfma_f32_16x16x32_bf16 v[192:195], a[120:123], v[104:107], v[192:195]
  ds_read_b64_tr_b16 v[100:101], v10 offset:57344
  ds_read_b64_tr_b16 v[102:103], v10 offset:58368
  v_mfma_f32_16x16x32_bf16 v[196:199], a[124:127], v[104:107], v[196:199]
  v_mul_f32 v121, 0xbfb8aa3b, v121
  v_mfma_f32_16x16x32_bf16 v[200:203], v[104:107], v[104:107], v[200:203]
  s_waitcnt lgkmcnt(10)
  ds_write_b128 v141, v[120:123] offset:768
  v_mfma_f32_16x16x32_bf16 v[192:195], a[132:135], v[88:91], v[192:195]
  ds_read_b64_tr_b16 v[104:105], v10 offset:61440
  ds_read_b64_tr_b16 v[106:107], v10 offset:62464
  v_mfma_f32_16x16x32_bf16 v[196:199], a[136:139], v[88:91], v[196:199]
  s_waitcnt lgkmcnt(7)
  s_barrier
  v_rcp_f32 v156, v156
  v_mfma_f32_16x16x32_bf16 v[200:203], v[88:91], v[88:91], v[200:203]
  s_add_u32 m0, s24, 0
  v_add_u32 v11, 65536, v11
  v_mfma_f32_16x16x32_bf16 v[192:195], a[144:147], v[92:95], v[192:195]
  s_add_u32 s77, s7, 112640
  ds_read_b64_tr_b16 v[88:89], v11 offset:0
  ds_read_b64_tr_b16 v[90:91], v11 offset:1024
  v_mfma_f32_16x16x32_bf16 v[196:199], a[148:151], v[92:95], v[196:199]
  buffer_load_dwordx4 v124, s[36:39], s77 offen  lds
  v_mfma_f32_16x16x32_bf16 v[200:203], v[92:95], v[92:95], v[200:203]
  s_waitcnt lgkmcnt(7)
  v_rcp_f32 v157, v157
  v_mfma_f32_16x16x32_bf16 v[192:195], a[156:159], v[96:99], v[192:195]
  ds_read_b64_tr_b16 v[92:93], v11 offset:4096
  ds_read_b64_tr_b16 v[94:95], v11 offset:5120
  v_mfma_f32_16x16x32_bf16 v[196:199], a[160:163], v[96:99], v[196:199]
  v_rcp_f32 v158, v158
  v_mfma_f32_16x16x32_bf16 v[200:203], v[96:99], v[96:99], v[200:203]
  s_waitcnt lgkmcnt(7)
  s_add_u32 m0, s24, 4096
  v_rcp_f32 v159, v159
  v_mfma_f32_16x16x32_bf16 v[192:195], a[168:171], v[100:103], v[192:195]
  s_add_u32 s77, s7, 129024
  ds_read_b64_tr_b16 v[96:97], v11 offset:8192
  ds_read_b64_tr_b16 v[98:99], v11 offset:9216
  s_add_u32 s69, s68, 45056
  v_mfma_f32_16x16x32_bf16 v[196:199], a[172:175], v[100:103], v[196:199]
  buffer_load_dwordx4 v124, s[36:39], s77 offen  lds
  v_mul_f32 v156, v156, v160
  v_mfma_f32_16x16x32_bf16 v[200:203], v[100:103], v[100:103], v[200:203]
  s_waitcnt lgkmcnt(6)
  v_mul_f32 v157, v157, v161
  v_mul_f32 v158, v158, v162
  v_mfma_f32_16x16x32_bf16 v[192:195], a[180:183], v[104:107], v[192:195]
  ds_read_b64_tr_b16 v[100:101], v11 offset:12288
  ds_read_b64_tr_b16 v[102:103], v11 offset:13312
  v_mfma_f32_16x16x32_bf16 v[196:199], a[184:187], v[104:107], v[196:199]
  v_mul_f32 v159, v159, v163
  v_cvt_pk_bf16_f32 v160, v156, v157
  v_mfma_f32_16x16x32_bf16 v[200:203], v[104:107], v[104:107], v[200:203]
  s_waitcnt lgkmcnt(6)
  s_add_u32 m0, s24, 8192
  v_cvt_pk_bf16_f32 v161, v158, v159
  v_cndmask_b32 v161, v161, 0, s[70:71]
  v_mfma_f32_16x16x32_bf16 v[204:207], a[0:3], v[88:91], 0
  s_add_u32 s77, s7, 145408
  ds_read_b64_tr_b16 v[104:105], v11 offset:16384
  ds_read_b64_tr_b16 v[106:107], v11 offset:17408
  v_mfma_f32_16x16x32_bf16 v[208:211], a[4:7], v[88:91], 0
  buffer_load_dwordx4 v124, s[36:39], s77 offen  lds
  v_mfma_f32_16x16x32_bf16 v[212:215], v[88:91], v[88:91], 0
  s_waitcnt lgkmcnt(6)
  buffer_store_dwordx2 v[160:161], v13, s[44:47], s69 offen
  v_fmac_f32 v168, v108, v76
  v_mfma_f32_16x16x32_bf16 v[204:207], a[12:15], v[92:95], v[204:207]
  ds_read_b64_tr_b16 v[88:89], v11 offset:20480
  ds_read_b64_tr_b16 v[90:91], v11 offset:21504
  v_mfma_f32_16x16x32_bf16 v[208:211], a[16:19], v[92:95], v[208:211]
  ds_bpermute_b32 v120, v15, v194
  v_cndmask_b32 v116, v200, v201, s[72:73]
  v_mfma_f32_16x16x32_bf16 v[212:215], v[92:95], v[92:95], v[212:215]
  s_waitcnt lgkmcnt(7)
  s_add_u32 m0, s24, 12288
  v_cndmask_b32 v117, v202, v203, s[72:73]
  v_cndmask_b32 v116, v116, v117, s[78:79]
  v_mfma_f32_16x16x32_bf16 v[204:207], a[24:27], v[96:99], v[204:207]
  s_add_u32 s77, s7, 161792
  ds_read_b64_tr_b16 v[92:93], v11 offset:24576
  ds_read_b64_tr_b16 v[94:95], v11 offset:25600
  v_mfma_f32_16x16x32_bf16 v[208:211], a[28:31], v[96:99], v[208:211]
  buffer_load_dwordx4 v124, s[36:39], s77 offen  lds
  v_mul_f32 v116, 0x3b000000, v116
  v_mfma_f32_16x16x32_bf16 v[212:215], v[96:99], v[96:99], v[212:215]
  s_waitcnt lgkmcnt(2)
  v_mul_f32 v120, 0xbb000000, v120
  v_fma_f32 v116, -v120, v120, v116
  v_mfma_f32_16x16x32_bf16 v[204:207], a[36:39], v[100:103], v[204:207]
  ds_read_b64_tr_b16 v[96:97], v11 offset:28672
  ds_read_b64_tr_b16 v[98:99], v11 offset:29696
  v_mfma_f32_16x16x32_bf16 v[208:211], a[40:43], v[100:103], v[208:211]
  v_max_f32 v116, 0, v116
  v_add_f32 v116, 0x3727c5ac, v116
  v_mfma_f32_16x16x32_bf16 v[212:215], v[100:103], v[100:103], v[212:215]
  s_add_u32 m0, s24, 16384
  v_rsq_f32 v121, v116
  v_mfma_f32_16x16x32_bf16 v[204:207], a[48:51], v[104:107], v[204:207]
  s_add_u32 s77, s7, 176128
  ds_read_b64_tr_b16 v[100:101], v11 offset:32768
  ds_read_b64_tr_b16 v[102:103], v11 offset:33792
  v_mfma_f32_16x16x32_bf16 v[208:211], a[52:55], v[104:107], v[208:211]
  buffer_load_dwordx4 v124, s[36:39], s77 offen  lds
  v_add_u32 v123, 5, v143
  v_mfma_f32_16x16x32_bf16 v[212:215], v[104:107], v[104:107], v[212:215]
  v_mul_f32 v122, v116, v121
  v_mul_f32 v121, 0xbfb8aa3b, v121
  v_mfma_f32_16x16x32_bf16 v[204:207], a[60:63], v[88:91], v[204:207]
  ds_read_b64_tr_b16 v[104:105], v11 offset:36864
  ds_read_b64_tr_b16 v[106:107], v11 offset:37888
  v_mfma_f32_16x16x32_bf16 v[208:211], a[64:67], v[88:91], v[208:211]
  ds_write_b128 v141, v[120:123] offset:1024
  v_fmac_f32 v169, v108, v77
  v_mfma_f32_16x16x32_bf16 v[212:215], v[88:91], v[88:91], v[212:215]
  s_waitcnt lgkmcnt(7)
  s_add_u32 m0, s24, 20480
  v_fmac_f32 v170, v108, v78
  v_fmac_f32 v171, v108, v79
  v_mfma_f32_16x16x32_bf16 v[204:207], a[72:75], v[92:95], v[204:207]
  s_add_u32 s77, s7, 192512
  ds_read_b64_tr_b16 v[88:89], v11 offset:40960
  ds_read_b64_tr_b16 v[90:91], v11 offset:41984
  v_mfma_f32_16x16x32_bf16 v[208:211], a[76:79], v[92:95], v[208:211]
  buffer_load_dwordx4 v124, s[36:39], s77 offen  lds
  v_mul_f32 v168, v168, v109
  v_mfma_f32_16x16x32_bf16 v[212:215], v[92:95], v[92:95], v[212:215]
  s_waitcnt lgkmcnt(7)
  v_mul_f32 v169, v169, v109
  v_mul_f32 v170, v170, v109
  v_mfma_f32_16x16x32_bf16 v[204:207], a[84:87], v[96:99], v[204:207]
  ds_read_b64_tr_b16 v[92:93], v11 offset:45056
  ds_read_b64_tr_b16 v[94:95], v11 offset:46080
  v_mfma_f32_16x16x32_bf16 v[208:211], a[88:91], v[96:99], v[208:211]
  v_mul_f32 v171, v171, v109
  v_mfma_f32_16x16x32_bf16 v[212:215], v[96:99], v[96:99], v[212:215]
  s_waitcnt lgkmcnt(7)
  s_add_u32 m0, s24, 24576
  v_exp_f32 v168, v168
  v_mfma_f32_16x16x32_bf16 v[204:207], a[96:99], v[100:103], v[204:207]
  s_add_u32 s77, s7, 208896
  ds_read_b64_tr_b16 v[96:97], v11 offset:49152
  ds_read_b64_tr_b16 v[98:99], v11 offset:50176
  v_mfma_f32_16x16x32_bf16 v[208:211], a[100:103], v[100:103], v[208:211]
  buffer_load_dwordx4 v124, s[36:39], s77 offen  lds
  v_mfma_f32_16x16x32_bf16 v[212:215], v[100:103], v[100:103], v[212:215]
  s_waitcnt lgkmcnt(7)
  v_exp_f32 v169, v169
  v_mfma_f32_16x16x32_bf16 v[204:207], a[108:111], v[104:107], v[204:207]
  ds_read_b64_tr_b16 v[100:101], v11 offset:53248
  ds_read_b64_tr_b16 v[102:103], v11 offset:54272
  v_mfma_f32_16x16x32_bf16 v[208:211], a[112:115], v[104:107], v[208:211]
  v_exp_f32 v170, v170
  v_mfma_f32_16x16x32_bf16 v[212:215], v[104:107], v[104:107], v[212:215]
  s_waitcnt lgkmcnt(6)
  s_add_u32 m0, s24, 28672
  v_exp_f32 v171, v171
  v_mfma_f32_16x16x32_bf16 v[204:207], a[120:123], v[88:91], v[204:207]
  s_add_u32 s77, s7, 225280
  ds_read_b64_tr_b16 v[104:105], v11 offset:57344
  ds_read_b64_tr_b16 v[106:107], v11 offset:58368
  v_mfma_f32_16x16x32_bf16 v[208:211], a[124:127], v[88:91], v[208:211]
  buffer_load_dwordx4 v124, s[36:39], s77 offen  lds
  ds_read_b128 v[112:115], v12 offset:768
  v_mfma_f32_16x16x32_bf16 v[212:215], v[88:91], v[88:91], v[212:215]
  s_waitcnt lgkmcnt(7)
  v_fmac_f32 v172, v108, v80
  v_fmac_f32 v173, v108, v81
  v_mfma_f32_16x16x32_bf16 v[204:207], a[132:135], v[92:95], v[204:207]
  ds_read_b64_tr_b16 v[88:89], v11 offset:61440
  ds_read_b64_tr_b16 v[90:91], v11 offset:62464
  v_mfma_f32_16x16x32_bf16 v[208:211], a[136:139], v[92:95], v[208:211]
  v_fmac_f32 v174, v108, v82
  v_fmac_f32 v175, v108, v83
  v_mfma_f32_16x16x32_bf16 v[212:215], v[92:95], v[92:95], v[212:215]
  s_waitcnt lgkmcnt(7)
  s_add_u32 m0, s24, 32768
  v_fma_f32 v168, v168, v110, v110
  v_add_u32 v139, 65536, v139
  v_mfma_f32_16x16x32_bf16 v[204:207], a[144:147], v[96:99], v[204:207]
  s_add_u32 s77, s7, 241664
  ds_read_b64_tr_b16 v[92:93], v139 offset:0
  ds_read_b64_tr_b16 v[94:95], v139 offset:1024
  v_mfma_f32_16x16x32_bf16 v[208:211], a[148:151], v[96:99], v[208:211]
  buffer_load_dwordx4 v124, s[36:39], s77 offen  lds
  v_fma_f32 v169, v169, v110, v110
  v_mfma_f32_16x16x32_bf16 v[212:215], v[96:99], v[96:99], v[212:215]
  s_waitcnt lgkmcnt(7)
  v_fma_f32 v170, v170, v110, v110
  v_fma_f32 v171, v171, v110, v110
  v_mfma_f32_16x16x32_bf16 v[204:207], a[156:159], v[100:103], v[204:207]
  ds_read_b64_tr_b16 v[96:97], v139 offset:4096
  ds_read_b64_tr_b16 v[98:99], v139 offset:5120
  v_mfma_f32_16x16x32_bf16 v[208:211], a[160:163], v[100:103], v[208:211]
  v_rcp_f32 v168, v168
  v_mfma_f32_16x16x32_bf16 v[212:215], v[100:103], v[100:103], v[212:215]
  s_waitcnt lgkmcnt(7)
  s_add_u32 m0, s24, 36864
  v_rcp_f32 v169, v169
  v_mfma_f32_16x16x32_bf16 v[204:207], a[168:171], v[104:107], v[204:207]
  s_add_u32 s77, s74, 258048
  ds_read_b64_tr_b16 v[100:101], v139 offset:8192
  ds_read_b64_tr_b16 v[102:103], v139 offset:9216
  v_mfma_f32_16x16x32_bf16 v[208:211], a[172:175], v[104:107], v[208:211]
  buffer_load_dwordx4 v124, s[36:39], s77 offen  lds
  v_mfma_f32_16x16x32_bf16 v[212:215], v[104:107], v[104:107], v[212:215]
  s_waitcnt lgkmcnt(6)
  v_rcp_f32 v170, v170
  v_mfma_f32_16x16x32_bf16 v[204:207], a[180:183], v[88:91], v[204:207]
  ds_read_b64_tr_b16 v[104:105], v139 offset:12288
  ds_read_b64_tr_b16 v[106:107], v139 offset:13312
  v_mfma_f32_16x16x32_bf16 v[208:211], a[184:187], v[88:91], v[208:211]
  v_rcp_f32 v171, v171
  v_mfma_f32_16x16x32_bf16 v[212:215], v[88:91], v[88:91], v[212:215]
  s_waitcnt lgkmcnt(6)
  s_add_u32 m0, s24, 40960
  s_add_u32 s69, s68, 90112
  v_mul_f32 v168, v168, v172
  v_mul_f32 v169, v169, v173
  v_mfma_f32_16x16x32_bf16 v[216:219], a[0:3], v[92:95], 0
  s_add_u32 s77, s7, 272384
  ds_read_b64_tr_b16 v[88:89], v139 offset:16384
  ds_read_b64_tr_b16 v[90:91], v139 offset:17408
  v_mfma_f32_16x16x32_bf16 v[220:223], a[4:7], v[92:95], 0
  buffer_load_dwordx4 v124, s[36:39], s77 offen  lds
  v_mul_f32 v170, v170, v174
  v_mfma_f32_16x16x32_bf16 v[224:227], v[92:95], v[92:95], 0
  s_waitcnt lgkmcnt(6)
  v_mul_f32 v171, v171, v175
  v_cvt_pk_bf16_f32 v172, v168, v169
  v_mfma_f32_16x16x32_bf16 v[216:219], a[12:15], v[96:99], v[216:219]
  ds_read_b64_tr_b16 v[92:93], v139 offset:20480
  ds_read_b64_tr_b16 v[94:95], v139 offset:21504
  v_mfma_f32_16x16x32_bf16 v[220:223], a[16:19], v[96:99], v[220:223]
  ds_bpermute_b32 v120, v15, v206
  v_cndmask_b32 v116, v212, v213, s[72:73]
  v_mfma_f32_16x16x32_bf16 v[224:227], v[96:99], v[96:99], v[224:227]
  s_waitcnt lgkmcnt(7)
  s_add_u32 m0, s24, 45056
  v_cndmask_b32 v117, v214, v215, s[72:73]
  v_cndmask_b32 v116, v116, v117, s[78:79]
  v_mfma_f32_16x16x32_bf16 v[216:219], a[24:27], v[100:103], v[216:219]
  s_add_u32 s77, s7, 288768
  ds_read_b64_tr_b16 v[96:97], v139 offset:24576
  ds_read_b64_tr_b16 v[98:99], v139 offset:25600
  v_mfma_f32_16x16x32_bf16 v[220:223], a[28:31], v[100:103], v[220:223]
  buffer_load_dwordx4 v124, s[36:39], s77 offen  lds
  v_mul_f32 v116, 0x3b000000, v116
  v_mfma_f32_16x16x32_bf16 v[224:227], v[100:103], v[100:103], v[224:227]
  s_waitcnt lgkmcnt(2)
  v_mul_f32 v120, 0xbb000000, v120
  v_fma_f32 v116, -v120, v120, v116
  v_mfma_f32_16x16x32_bf16 v[216:219], a[36:39], v[104:107], v[216:219]
  ds_read_b64_tr_b16 v[100:101], v139 offset:28672
  ds_read_b64_tr_b16 v[102:103], v139 offset:29696
  v_mfma_f32_16x16x32_bf16 v[220:223], a[40:43], v[104:107], v[220:223]
  v_max_f32 v116, 0, v116
  v_add_f32 v116, 0x3727c5ac, v116
  v_mfma_f32_16x16x32_bf16 v[224:227], v[104:107], v[104:107], v[224:227]
  s_add_u32 m0, s24, 49152
  v_rsq_f32 v121, v116
  v_mfma_f32_16x16x32_bf16 v[216:219], a[48:51], v[88:91], v[216:219]
  s_add_u32 s77, s7, 305152
  ds_read_b64_tr_b16 v[104:105], v139 offset:32768
  ds_read_b64_tr_b16 v[106:107], v139 offset:33792
  v_mfma_f32_16x16x32_bf16 v[220:223], a[52:55], v[88:91], v[220:223]
  buffer_load_dwordx4 v124, s[36:39], s77 offen  lds
  v_add_u32 v123, 6, v143
  v_mfma_f32_16x16x32_bf16 v[224:227], v[88:91], v[88:91], v[224:227]
  v_mul_f32 v122, v116, v121
  v_mul_f32 v121, 0xbfb8aa3b, v121
  v_mfma_f32_16x16x32_bf16 v[216:219], a[60:63], v[92:95], v[216:219]
  ds_read_b64_tr_b16 v[88:89], v139 offset:36864
  ds_read_b64_tr_b16 v[90:91], v139 offset:37888
  v_mfma_f32_16x16x32_bf16 v[220:223], a[64:67], v[92:95], v[220:223]
  ds_write_b128 v141, v[120:123] offset:1280
  v_cvt_pk_bf16_f32 v173, v170, v171
  v_mfma_f32_16x16x32_bf16 v[224:227], v[92:95], v[92:95], v[224:227]
  s_waitcnt lgkmcnt(7)
  s_add_u32 m0, s24, 53248
  v_cndmask_b32 v173, v173, 0, s[70:71]
  v_mfma_f32_16x16x32_bf16 v[216:219], a[72:75], v[96:99], v[216:219]
  s_add_u32 s77, s7, 321536
  ds_read_b64_tr_b16 v[92:93], v139 offset:40960
  ds_read_b64_tr_b16 v[94:95], v139 offset:41984
  v_mfma_f32_16x16x32_bf16 v[220:223], a[76:79], v[96:99], v[220:223]
  buffer_load_dwordx4 v124, s[36:39], s77 offen  lds
  v_mfma_f32_16x16x32_bf16 v[224:227], v[96:99], v[96:99], v[224:227]
  s_waitcnt lgkmcnt(7)
  buffer_store_dwordx2 v[172:173], v13, s[44:47], s69 offen
  v_fmac_f32 v180, v112, v76
  v_mfma_f32_16x16x32_bf16 v[216:219], a[84:87], v[100:103], v[216:219]
  ds_read_b64_tr_b16 v[96:97], v139 offset:45056
  ds_read_b64_tr_b16 v[98:99], v139 offset:46080
  v_mfma_f32_16x16x32_bf16 v[220:223], a[88:91], v[100:103], v[220:223]
  v_fmac_f32 v181, v112, v77
  v_fmac_f32 v182, v112, v78
  v_mfma_f32_16x16x32_bf16 v[224:227], v[100:103], v[100:103], v[224:227]
  s_waitcnt lgkmcnt(7)
  s_add_u32 m0, s24, 57344
  v_fmac_f32 v183, v112, v79
  v_mul_f32 v180, v180, v113
  v_mfma_f32_16x16x32_bf16 v[216:219], a[96:99], v[104:107], v[216:219]
  s_add_u32 s77, s7, 337920
  ds_read_b64_tr_b16 v[100:101], v139 offset:49152
  ds_read_b64_tr_b16 v[102:103], v139 offset:50176
  v_mfma_f32_16x16x32_bf16 v[220:223], a[100:103], v[104:107], v[220:223]
  buffer_load_dwordx4 v124, s[36:39], s77 offen  lds
  v_mul_f32 v181, v181, v113
  v_mfma_f32_16x16x32_bf16 v[224:227], v[104:107], v[104:107], v[224:227]
  s_waitcnt lgkmcnt(7)
  v_mul_f32 v182, v182, v113
  v_mul_f32 v183, v183, v113
  v_mfma_f32_16x16x32_bf16 v[216:219], a[108:111], v[88:91], v[216:219]
  ds_read_b64_tr_b16 v[104:105], v139 offset:53248
  ds_read_b64_tr_b16 v[106:107], v139 offset:54272
  v_mfma_f32_16x16x32_bf16 v[220:223], a[112:115], v[88:91], v[220:223]
  v_exp_f32 v180, v180
  v_mfma_f32_16x16x32_bf16 v[224:227], v[88:91], v[88:91], v[224:227]
  s_waitcnt lgkmcnt(6)
  s_add_u32 m0, s24, 61440
  v_exp_f32 v181, v181
  v_mfma_f32_16x16x32_bf16 v[216:219], a[120:123], v[92:95], v[216:219]
  s_add_u32 s77, s9, 352256
  ds_read_b64_tr_b16 v[88:89], v139 offset:57344
  ds_read_b64_tr_b16 v[90:91], v139 offset:58368
  v_mfma_f32_16x16x32_bf16 v[220:223], a[124:127], v[92:95], v[220:223]
  buffer_load_dwordx4 v124, s[36:39], s77 offen  lds
  v_mfma_f32_16x16x32_bf16 v[224:227], v[92:95], v[92:95], v[224:227]
  s_waitcnt lgkmcnt(6)
  v_exp_f32 v182, v182
  v_mfma_f32_16x16x32_bf16 v[216:219], a[132:135], v[96:99], v[216:219]
  ds_read_b64_tr_b16 v[92:93], v139 offset:61440
  ds_read_b64_tr_b16 v[94:95], v139 offset:62464
  v_mfma_f32_16x16x32_bf16 v[220:223], a[136:139], v[96:99], v[220:223]
  v_exp_f32 v183, v183
  v_mfma_f32_16x16x32_bf16 v[224:227], v[96:99], v[96:99], v[224:227]
  s_waitcnt lgkmcnt(6)
  s_add_u32 m0, s24, 135168
  ds_read_b128 v[108:111], v12 offset:1024
  v_add_u32 v140, 65536, v140
  v_mfma_f32_16x16x32_bf16 v[216:219], a[144:147], v[100:103], v[216:219]
  s_add_u32 s77, s9, 368640
  ds_read_b64_tr_b16 v[96:97], v140 offset:0
  ds_read_b64_tr_b16 v[98:99], v140 offset:1024
  v_mfma_f32_16x16x32_bf16 v[220:223], a[148:151], v[100:103], v[220:223]
  buffer_load_dwordx4 v124, s[36:39], s77 offen  lds
  v_fmac_f32 v184, v112, v80
  v_mfma_f32_16x16x32_bf16 v[224:227], v[100:103], v[100:103], v[224:227]
  s_waitcnt lgkmcnt(7)
  v_fmac_f32 v185, v112, v81
  v_fmac_f32 v186, v112, v82
  v_mfma_f32_16x16x32_bf16 v[216:219], a[156:159], v[104:107], v[216:219]
  ds_read_b64_tr_b16 v[100:101], v140 offset:4096
  ds_read_b64_tr_b16 v[102:103], v140 offset:5120
  v_mfma_f32_16x16x32_bf16 v[220:223], a[160:163], v[104:107], v[220:223]
  v_fmac_f32 v187, v112, v83
  v_fma_f32 v180, v180, v114, v114
  v_mfma_f32_16x16x32_bf16 v[224:227], v[104:107], v[104:107], v[224:227]
  s_waitcnt lgkmcnt(7)
  s_add_u32 m0, s24, 139264
  v_fma_f32 v181, v181, v114, v114
  v_fma_f32 v182, v182, v114, v114
  v_mfma_f32_16x16x32_bf16 v[216:219], a[168:171], v[88:91], v[216:219]
  s_add_u32 s77, s9, 385024
  ds_read_b64_tr_b16 v[104:105], v140 offset:8192
  ds_read_b64_tr_b16 v[106:107], v140 offset:9216
  v_mfma_f32_16x16x32_bf16 v[220:223], a[172:175], v[88:91], v[220:223]
  buffer_load_dwordx4 v124, s[36:39], s77 offen  lds
  v_fma_f32 v183, v183, v114, v114
  v_mfma_f32_16x16x32_bf16 v[224:227], v[88:91], v[88:91], v[224:227]
  s_waitcnt lgkmcnt(7)
  v_rcp_f32 v180, v180
  v_mfma_f32_16x16x32_bf16 v[216:219], a[180:183], v[92:95], v[216:219]
  ds_read_b64_tr_b16 v[88:89], v140 offset:12288
  ds_read_b64_tr_b16 v[90:91], v140 offset:13312
  v_mfma_f32_16x16x32_bf16 v[220:223], a[184:187], v[92:95], v[220:223]
  v_rcp_f32 v181, v181
  v_mfma_f32_16x16x32_bf16 v[224:227], v[92:95], v[92:95], v[224:227]
  s_waitcnt lgkmcnt(6)
  s_add_u32 m0, s24, 143360
  v_rcp_f32 v182, v182
  v_mfma_f32_16x16x32_bf16 v[228:231], a[0:3], v[96:99], 0
  s_add_u32 s77, s9, 401408
  ds_read_b64_tr_b16 v[92:93], v140 offset:16384
  ds_read_b64_tr_b16 v[94:95], v140 offset:17408
  v_mfma_f32_16x16x32_bf16 v[232:235], a[4:7], v[96:99], 0
  buffer_load_dwordx4 v124, s[36:39], s77 offen  lds
  v_mfma_f32_16x16x32_bf16 v[236:239], v[96:99], v[96:99], 0
  s_waitcnt lgkmcnt(6)
  v_rcp_f32 v183, v183
  v_mfma_f32_16x16x32_bf16 v[228:231], a[12:15], v[100:103], v[228:231]
  ds_read_b64_tr_b16 v[96:97], v140 offset:20480
  ds_read_b64_tr_b16 v[98:99], v140 offset:21504
  s_add_u32 s69, s68, 135168
  v_mfma_f32_16x16x32_bf16 v[232:235], a[16:19], v[100:103], v[232:235]
  ds_bpermute_b32 v120, v15, v218
  v_cndmask_b32 v116, v224, v225, s[72:73]
  v_mfma_f32_16x16x32_bf16 v[236:239], v[100:103], v[100:103], v[236:239]
  s_waitcnt lgkmcnt(7)
  s_add_u32 m0, s24, 147456
  v_cndmask_b32 v117, v226, v227, s[72:73]
  v_cndmask_b32 v116, v116, v117, s[78:79]
  v_mfma_f32_16x16x32_bf16 v[228:231], a[24:27], v[104:107], v[228:231]
  s_add_u32 s77, s9, 417792
  ds_read_b64_tr_b16 v[100:101], v140 offset:24576
  ds_read_b64_tr_b16 v[102:103], v140 offset:25600
  v_mfma_f32_16x16x32_bf16 v[232:235], a[28:31], v[104:107], v[232:235]
  buffer_load_dwordx4 v124, s[36:39], s77 offen  lds
  v_mul_f32 v116, 0x3b000000, v116
  v_mfma_f32_16x16x32_bf16 v[236:239], v[104:107], v[104:107], v[236:239]
  s_waitcnt lgkmcnt(2)
  v_mul_f32 v120, 0xbb000000, v120
  v_fma_f32 v116, -v120, v120, v116
  v_mfma_f32_16x16x32_bf16 v[228:231], a[36:39], v[88:91], v[228:231]
  ds_read_b64_tr_b16 v[104:105], v140 offset:28672
  ds_read_b64_tr_b16 v[106:107], v140 offset:29696
  v_mfma_f32_16x16x32_bf16 v[232:235], a[40:43], v[88:91], v[232:235]
  v_max_f32 v116, 0, v116
  v_add_f32 v116, 0x3727c5ac, v116
  v_mfma_f32_16x16x32_bf16 v[236:239], v[88:91], v[88:91], v[236:239]
  s_add_u32 m0, s24, 151552
  v_rsq_f32 v121, v116
  v_mfma_f32_16x16x32_bf16 v[228:231], a[48:51], v[92:95], v[228:231]
  s_add_u32 s77, s10, 434176
  ds_read_b64_tr_b16 v[88:89], v140 offset:32768
  ds_read_b64_tr_b16 v[90:91], v140 offset:33792
  v_mfma_f32_16x16x32_bf16 v[232:235], a[52:55], v[92:95], v[232:235]
  buffer_load_dwordx4 v124, s[36:39], s77 offen  lds
  v_add_u32 v123, 7, v143
  v_mfma_f32_16x16x32_bf16 v[236:239], v[92:95], v[92:95], v[236:239]
  v_mul_f32 v122, v116, v121
  v_mul_f32 v121, 0xbfb8aa3b, v121
  v_mfma_f32_16x16x32_bf16 v[228:231], a[60:63], v[96:99], v[228:231]
  ds_read_b64_tr_b16 v[92:93], v140 offset:36864
  ds_read_b64_tr_b16 v[94:95], v140 offset:37888
  v_mfma_f32_16x16x32_bf16 v[232:235], a[64:67], v[96:99], v[232:235]
  ds_write_b128 v141, v[120:123] offset:1536
  v_mul_f32 v180, v180, v184
  v_mfma_f32_16x16x32_bf16 v[236:239], v[96:99], v[96:99], v[236:239]
  s_waitcnt lgkmcnt(7)
  s_add_u32 m0, s24, 155648
  v_mul_f32 v181, v181, v185
  v_mul_f32 v182, v182, v186
  v_mfma_f32_16x16x32_bf16 v[228:231], a[72:75], v[100:103], v[228:231]
  s_add_u32 s77, s9, 448512
  ds_read_b64_tr_b16 v[96:97], v140 offset:40960
  ds_read_b64_tr_b16 v[98:99], v140 offset:41984
  v_mfma_f32_16x16x32_bf16 v[232:235], a[76:79], v[100:103], v[232:235]
  buffer_load_dwordx4 v124, s[36:39], s77 offen  lds
  v_mul_f32 v183, v183, v187
  v_mfma_f32_16x16x32_bf16 v[236:239], v[100:103], v[100:103], v[236:239]
  s_waitcnt lgkmcnt(7)
  v_cvt_pk_bf16_f32 v184, v180, v181
  v_cvt_pk_bf16_f32 v185, v182, v183
  v_mfma_f32_16x16x32_bf16 v[228:231], a[84:87], v[104:107], v[228:231]
  ds_read_b64_tr_b16 v[100:101], v140 offset:45056
  ds_read_b64_tr_b16 v[102:103], v140 offset:46080
  v_mfma_f32_16x16x32_bf16 v[232:235], a[88:91], v[104:107], v[232:235]
  v_cndmask_b32 v185, v185, 0, s[70:71]
  v_mfma_f32_16x16x32_bf16 v[236:239], v[104:107], v[104:107], v[236:239]
  s_waitcnt lgkmcnt(7)
  s_add_u32 m0, s24, 159744
  buffer_store_dwordx2 v[184:185], v13, s[44:47], s69 offen
  v_fmac_f32 v192, v108, v76
  v_mfma_f32_16x16x32_bf16 v[228:231], a[96:99], v[88:91], v[228:231]
  s_add_u32 s77, s9, 464896
  ds_read_b64_tr_b16 v[104:105], v140 offset:49152
  ds_read_b64_tr_b16 v[106:107], v140 offset:50176
  v_mfma_f32_16x16x32_bf16 v[232:235], a[100:103], v[88:91], v[232:235]
  buffer_load_dwordx4 v124, s[36:39], s77 offen  lds
  v_fmac_f32 v193, v108, v77
  v_mfma_f32_16x16x32_bf16 v[236:239], v[88:91], v[88:91], v[236:239]
  s_waitcnt lgkmcnt(7)
  v_fmac_f32 v194, v108, v78
  v_fmac_f32 v195, v108, v79
  v_mfma_f32_16x16x32_bf16 v[228:231], a[108:111], v[92:95], v[228:231]
  ds_read_b64_tr_b16 v[88:89], v140 offset:53248
  ds_read_b64_tr_b16 v[90:91], v140 offset:54272
  v_mfma_f32_16x16x32_bf16 v[232:235], a[112:115], v[92:95], v[232:235]
  v_mul_f32 v192, v192, v109
  v_mul_f32 v193, v193, v109
  v_mfma_f32_16x16x32_bf16 v[236:239], v[92:95], v[92:95], v[236:239]
  s_waitcnt lgkmcnt(6)
  v_mul_f32 v194, v194, v109
  v_mul_f32 v195, v195, v109
  v_mfma_f32_16x16x32_bf16 v[228:231], a[120:123], v[96:99], v[228:231]
  ds_read_b64_tr_b16 v[92:93], v140 offset:57344
  ds_read_b64_tr_b16 v[94:95], v140 offset:58368
  v_mfma_f32_16x16x32_bf16 v[232:235], a[124:127], v[96:99], v[232:235]
  v_exp_f32 v192, v192
  v_mfma_f32_16x16x32_bf16 v[236:239], v[96:99], v[96:99], v[236:239]
  s_waitcnt lgkmcnt(6)
  v_exp_f32 v193, v193
  v_mfma_f32_16x16x32_bf16 v[228:231], a[132:135], v[100:103], v[228:231]
  ds_read_b64_tr_b16 v[96:97], v140 offset:61440
  ds_read_b64_tr_b16 v[98:99], v140 offset:62464
  v_mfma_f32_16x16x32_bf16 v[232:235], a[136:139], v[100:103], v[232:235]
  v_exp_f32 v194, v194
  v_mfma_f32_16x16x32_bf16 v[236:239], v[100:103], v[100:103], v[236:239]
  s_waitcnt lgkmcnt(6)
  v_exp_f32 v195, v195
  v_mfma_f32_16x16x32_bf16 v[228:231], a[144:147], v[104:107], v[228:231]
  ds_read_b128 v[112:115], v12 offset:1280
  v_fmac_f32 v196, v108, v80
  v_mfma_f32_16x16x32_bf16 v[232:235], a[148:151], v[104:107], v[232:235]
  v_fmac_f32 v197, v108, v81
  v_fmac_f32 v198, v108, v82
  v_mfma_f32_16x16x32_bf16 v[236:239], v[104:107], v[104:107], v[236:239]
  s_waitcnt lgkmcnt(5)
  v_fmac_f32 v199, v108, v83
  v_fma_f32 v192, v192, v110, v110
  v_mfma_f32_16x16x32_bf16 v[228:231], a[156:159], v[88:91], v[228:231]
  v_fma_f32 v193, v193, v110, v110
  v_fma_f32 v194, v194, v110, v110
  v_mfma_f32_16x16x32_bf16 v[232:235], a[160:163], v[88:91], v[232:235]
  v_fma_f32 v195, v195, v110, v110
  v_mfma_f32_16x16x32_bf16 v[236:239], v[88:91], v[88:91], v[236:239]
  s_waitcnt lgkmcnt(3)
  v_rcp_f32 v192, v192
  v_mfma_f32_16x16x32_bf16 v[228:231], a[168:171], v[92:95], v[228:231]
  v_rcp_f32 v193, v193
  v_mfma_f32_16x16x32_bf16 v[232:235], a[172:175], v[92:95], v[232:235]
  v_rcp_f32 v194, v194
  v_mfma_f32_16x16x32_bf16 v[236:239], v[92:95], v[92:95], v[236:239]
  s_waitcnt lgkmcnt(1)
  v_rcp_f32 v195, v195
  v_mfma_f32_16x16x32_bf16 v[228:231], a[180:183], v[96:99], v[228:231]
  s_add_u32 s69, s68, 180224
  v_mul_f32 v192, v192, v196
  v_mul_f32 v193, v193, v197
  v_mfma_f32_16x16x32_bf16 v[232:235], a[184:187], v[96:99], v[232:235]
  v_mul_f32 v194, v194, v198
  v_mul_f32 v195, v195, v199
  v_mfma_f32_16x16x32_bf16 v[236:239], v[96:99], v[96:99], v[236:239]
  v_cvt_pk_bf16_f32 v196, v192, v193
  v_cvt_pk_bf16_f32 v197, v194, v195
  s_nop 7
  ds_bpermute_b32 v120, v15, v230
  v_cndmask_b32 v116, v236, v237, s[72:73]
  v_cndmask_b32 v117, v238, v239, s[72:73]
  v_cndmask_b32 v116, v116, v117, s[78:79]
  v_mul_f32 v116, 0x3b000000, v116
  s_waitcnt lgkmcnt(0)
  v_mul_f32 v120, 0xbb000000, v120
  v_fma_f32 v116, -v120, v120, v116
  v_max_f32 v116, 0, v116
  v_add_f32 v116, 0x3727c5ac, v116
  v_rsq_f32 v121, v116
  v_add_u32 v123, 8, v143
  v_mul_f32 v122, v116, v121
  v_mul_f32 v121, 0xbfb8aa3b, v121
  ds_write_b128 v141, v[120:123] offset:1792
  v_cndmask_b32 v197, v197, 0, s[70:71]
  buffer_store_dwordx2 v[196:197], v13, s[44:47], s69 offen
  v_pk_fma_f32 v[204:205], v[112:113], v[76:77], v[204:205] op_sel_hi:[0,1,1]
  v_pk_fma_f32 v[206:207], v[112:113], v[78:79], v[206:207] op_sel_hi:[0,1,1]
  v_pk_mul_f32 v[204:205], v[204:205], v[112:113] op_sel:[0,1]
  v_pk_mul_f32 v[206:207], v[206:207], v[112:113] op_sel:[0,1]
  v_exp_f32 v204, v204
  v_exp_f32 v205, v205
  v_exp_f32 v206, v206
  v_exp_f32 v207, v207
  ds_read_b128 v[108:111], v12 offset:1536
  v_pk_fma_f32 v[208:209], v[112:113], v[80:81], v[208:209] op_sel_hi:[0,1,1]
  v_pk_fma_f32 v[210:211], v[112:113], v[82:83], v[210:211] op_sel_hi:[0,1,1]
  v_pk_fma_f32 v[204:205], v[204:205], v[114:115], v[114:115] op_sel_hi:[1,0,0]
  v_pk_fma_f32 v[206:207], v[206:207], v[114:115], v[114:115] op_sel_hi:[1,0,0]
  v_rcp_f32 v204, v204
  v_rcp_f32 v205, v205
  v_rcp_f32 v206, v206
  v_rcp_f32 v207, v207
  s_add_u32 s69, s68, 225280
  v_pk_mul_f32 v[204:205], v[204:205], v[208:209]
  v_pk_mul_f32 v[206:207], v[206:207], v[210:211]
  v_cvt_pk_bf16_f32 v208, v204, v205
  v_cvt_pk_bf16_f32 v209, v206, v207
  v_cndmask_b32 v209, v209, 0, s[70:71]
  buffer_store_dwordx2 v[208:209], v13, s[44:47], s69 offen
  s_waitcnt lgkmcnt(0)
  v_pk_fma_f32 v[216:217], v[108:109], v[76:77], v[216:217] op_sel_hi:[0,1,1]
  v_pk_fma_f32 v[218:219], v[108:109], v[78:79], v[218:219] op_sel_hi:[0,1,1]
  v_pk_mul_f32 v[216:217], v[216:217], v[108:109] op_sel:[0,1]
  v_pk_mul_f32 v[218:219], v[218:219], v[108:109] op_sel:[0,1]
  v_exp_f32 v216, v216
  v_exp_f32 v217, v217
  v_exp_f32 v218, v218
  v_exp_f32 v219, v219
  ds_read_b128 v[112:115], v12 offset:1792
  v_pk_fma_f32 v[220:221], v[108:109], v[80:81], v[220:221] op_sel_hi:[0,1,1]
  v_pk_fma_f32 v[222:223], v[108:109], v[82:83], v[222:223] op_sel_hi:[0,1,1]
  v_pk_fma_f32 v[216:217], v[216:217], v[110:111], v[110:111] op_sel_hi:[1,0,0]
  v_pk_fma_f32 v[218:219], v[218:219], v[110:111], v[110:111] op_sel_hi:[1,0,0]
  v_rcp_f32 v216, v216
  v_rcp_f32 v217, v217
  v_rcp_f32 v218, v218
  v_rcp_f32 v219, v219
  s_add_u32 s69, s68, 270336
  v_pk_mul_f32 v[216:217], v[216:217], v[220:221]
  v_pk_mul_f32 v[218:219], v[218:219], v[222:223]
  v_cvt_pk_bf16_f32 v220, v216, v217
  v_cvt_pk_bf16_f32 v221, v218, v219
  v_cndmask_b32 v221, v221, 0, s[70:71]
  buffer_store_dwordx2 v[220:221], v13, s[44:47], s69 offen
  s_waitcnt lgkmcnt(0)
  v_pk_fma_f32 v[228:229], v[112:113], v[76:77], v[228:229] op_sel_hi:[0,1,1]
  v_pk_fma_f32 v[230:231], v[112:113], v[78:79], v[230:231] op_sel_hi:[0,1,1]
  v_pk_mul_f32 v[228:229], v[228:229], v[112:113] op_sel:[0,1]
  v_pk_mul_f32 v[230:231], v[230:231], v[112:113] op_sel:[0,1]
  v_exp_f32 v228, v228
  v_exp_f32 v229, v229
  v_exp_f32 v230, v230
  v_exp_f32 v231, v231
  v_pk_fma_f32 v[232:233], v[112:113], v[80:81], v[232:233] op_sel_hi:[0,1,1]
  v_pk_fma_f32 v[234:235], v[112:113], v[82:83], v[234:235] op_sel_hi:[0,1,1]
  v_pk_fma_f32 v[228:229], v[228:229], v[114:115], v[114:115] op_sel_hi:[1,0,0]
  v_pk_fma_f32 v[230:231], v[230:231], v[114:115], v[114:115] op_sel_hi:[1,0,0]
  v_rcp_f32 v228, v228
  v_rcp_f32 v229, v229
  v_rcp_f32 v230, v230
  v_rcp_f32 v231, v231
  s_add_u32 s69, s68, 315392
  v_pk_mul_f32 v[228:229], v[228:229], v[232:233]
  v_pk_mul_f32 v[230:231], v[230:231], v[234:235]
  v_cvt_pk_bf16_f32 v232, v228, v229
  v_cvt_pk_bf16_f32 v233, v230, v231
  v_cndmask_b32 v233, v233, 0, s[70:71]
  buffer_store_dwordx2 v[232:233], v13, s[44:47], s69 offen
L_p2done:
  s_and_b32 s64, s58, 1
  s_lshl_b32 s64, s64, 3
  s_lshr_b32 s65, s59, 3
  s_lshl_b32 s65, s65, 2
  s_add_u32 s64, s64, s65
  s_add_u32 s64, s64, s56
  s_mul_i32 s64, s64, 45056
  s_add_u32 s64, s64, s22
  s_lshr_b32 s60, s55, 4
  s_mul_i32 s60, s60, 11264
  s_sub_u32 s65, s64, s60
  s_add_u32 s64, s64, s60
  v_and_b32 v2, 15, v0
  v_lshlrev_b32 v2, 4, v2
  v_bfe_u32 v3, v0, 4, 1
  v_lshl_add_u32 v2, v3, 10, v2
  v_bfe_u32 v3, v0, 5, 1
  v_lshl_add_u32 v2, v3, 8, v2
  s_lshr_b32 s60, s56, 1
  s_lshl_b32 s60, s60, 12
  v_add_u32 v3, s60, v2
  v_add_u32 v4, 65536, v3
  v_add_u32 v5, 131072, v3
  s_waitcnt vmcnt(0) lgkmcnt(0)
  s_barrier
  s_cmp_lg_u32 s56, 0
  s_cbranch_scc1 L_nof1c
  s_lshl_b32 s67, s58, 7
  s_add_u32 s67, s67, 86016
  s_add_u32 s68, s67, 4096
  s_lshl_b32 s69, s59, 3
  s_mov_b64 exec, 1
  v_mov_b32 v16, s2
  v_mov_b32 v17, s3
  v_mov_b32 v18, s69
  buffer_store_dwordx2 v[16:17], v18, s[44:47], s67 offen
  s_mov_b64 exec, -1
L_nof1c:
  s_add_u32 m0, s24, 65536
  s_add_u32 s77, s9, 481280
  buffer_load_dwordx4 v124, s[36:39], s77 offen  lds
  s_add_u32 m0, s24, 69632
  s_add_u32 s77, s9, 497664
  buffer_load_dwordx4 v124, s[36:39], s77 offen  lds
  s_add_u32 m0, s24, 73728
  s_add_u32 s77, s9, 514048
  buffer_load_dwordx4 v124, s[36:39], s77 offen  lds
  s_add_u32 m0, s24, 77824
  s_add_u32 s77, s9, 528384
  buffer_load_dwordx4 v124, s[36:39], s77 offen  lds
  s_add_u32 m0, s24, 81920
  s_add_u32 s77, s9, 544768
  buffer_load_dwordx4 v124, s[36:39], s77 offen  lds
  s_add_u32 m0, s24, 86016
  s_add_u32 s77, s9, 561152
  buffer_load_dwordx4 v124, s[36:39], s77 offen  lds
  s_add_u32 m0, s24, 90112
  s_add_u32 s77, s9, 577536
  buffer_load_dwordx4 v124, s[36:39], s77 offen  lds
  s_add_u32 m0, s24, 94208
  s_add_u32 s77, s9, 593920
  buffer_load_dwordx4 v124, s[36:39], s77 offen  lds
  s_add_u32 m0, s24, 98304
  s_add_u32 s77, s10, 610304
  buffer_load_dwordx4 v124, s[36:39], s77 offen  lds
  s_add_u32 m0, s24, 102400
  s_add_u32 s77, s9, 624640
  buffer_load_dwordx4 v124, s[36:39], s77 offen  lds
  s_add_u32 m0, s24, 106496
  s_add_u32 s77, s9, 641024
  buffer_load_dwordx4 v124, s[36:39], s77 offen  lds
  s_add_u32 m0, s24, 110592
  s_add_u32 s77, s9, 657408
  buffer_load_dwordx4 v124, s[36:39], s77 offen  lds
  s_add_u32 m0, s24, 114688
  s_add_u32 s77, s9, 673792
  buffer_load_dwordx4 v124, s[36:39], s77 offen  lds
  s_add_u32 m0, s24, 118784
  s_add_u32 s77, s9, 690176
  buffer_load_dwordx4 v124, s[36:39], s77 offen  lds
  v_add_u32 v138, 135168, v125
  ds_read_b64_tr_b16 v[172:173], v138 offset:0
  ds_read_b64_tr_b16 v[174:175], v138 offset:512
  ds_read_b64_tr_b16 v[176:177], v138 offset:4096
  ds_read_b64_tr_b16 v[178:179], v138 offset:4608
  ds_read_b64_tr_b16 v[180:181], v138 offset:8192
  ds_read_b64_tr_b16 v[182:183], v138 offset:8704
  ds_read_b64_tr_b16 v[184:185], v138 offset:12288
  ds_read_b64_tr_b16 v[186:187], v138 offset:12800
  ds_read_b64_tr_b16 v[188:189], v138 offset:16384
  ds_read_b64_tr_b16 v[190:191], v138 offset:16896
  ds_read_b64_tr_b16 v[192:193], v138 offset:20480
  ds_read_b64_tr_b16 v[194:195], v138 offset:20992
  ds_read_b64_tr_b16 v[196:197], v138 offset:24576
  ds_read_b64_tr_b16 v[198:199], v138 offset:25088
  v_add_u32 v139, 0, v125
  ds_read_b64_tr_b16 a[220:221], v139 offset:0
  ds_read_b64_tr_b16 a[222:223], v139 offset:512
  ds_read_b64_tr_b16 a[224:225], v139 offset:4096
  ds_read_b64_tr_b16 a[226:227], v139 offset:4608
  ds_read_b64_tr_b16 a[228:229], v139 offset:8192
  ds_read_b64_tr_b16 a[230:231], v139 offset:8704
  ds_read_b64_tr_b16 a[232:233], v139 offset:12288
  ds_read_b64_tr_b16 a[234:235], v139 offset:12800
  ds_read_b64_tr_b16 a[236:237], v139 offset:16384
  ds_read_b64_tr_b16 a[238:239], v139 offset:16896
  ds_read_b64_tr_b16 a[240:241], v139 offset:20480
  ds_read_b64_tr_b16 a[242:243], v139 offset:20992
  ds_read_b64_tr_b16 a[244:245], v139 offset:24576
  ds_read_b64_tr_b16 a[246:247], v139 offset:25088
  ds_read_b64_tr_b16 a[248:249], v139 offset:28672
  ds_read_b64_tr_b16 a[250:251], v139 offset:29184
  ds_read_b64_tr_b16 a[252:253], v139 offset:32768
  ds_read_b64_tr_b16 a[254:255], v139 offset:33280
  ds_read_b64_tr_b16 v[144:145], v139 offset:36864
  ds_read_b64_tr_b16 v[146:147], v139 offset:37376
  ds_read_b64_tr_b16 v[148:149], v139 offset:40960
  ds_read_b64_tr_b16 v[150:151], v139 offset:41472
  ds_read_b64_tr_b16 v[152:153], v139 offset:45056
  ds_read_b64_tr_b16 v[154:155], v139 offset:45568
  ds_read_b64_tr_b16 v[156:157], v139 offset:49152
  ds_read_b64_tr_b16 v[158:159], v139 offset:49664
  ds_read_b64_tr_b16 v[160:161], v139 offset:53248
  ds_read_b64_tr_b16 v[162:163], v139 offset:53760
  ds_read_b64_tr_b16 v[164:165], v139 offset:57344
  ds_read_b64_tr_b16 v[166:167], v139 offset:57856
  ds_read_b64_tr_b16 v[168:169], v139 offset:61440
  ds_read_b64_tr_b16 v[170:171], v139 offset:61952
  s_lshl_b32 s60, s56, 12
  s_xor_b32 s61, s60, 8192
  v_add_u32 v81, s61, v1
  v_add_u32 v80, s60, v1
  v_and_b32 v82, 31, v0
  v_lshlrev_b32 v82, 10, v82
  v_bfe_u32 v83, v0, 5, 1
  v_lshl_add_u32 v82, v83, 4, v82
  s_lshl_b32 s66, s58, 17
  s_lshr_b32 s63, s59, 3
  s_lshl_b32 s63, s63, 16
  s_add_u32 s66, s66, s63
  s_lshr_b32 s63, s56, 1
  s_lshl_b32 s63, s63, 15
  s_add_u32 s66, s66, s63
  s_and_b32 s63, s59, 7
  s_lshl_b32 s63, s63, 7
  s_add_u32 s66, s66, s63
  s_and_b32 s63, s56, 1
  s_lshl_b32 s63, s63, 6
  s_add_u32 s66, s66, s63
  v_lshlrev_b32 v84, 16, v128
  v_and_b32 v85, s82, v128
  v_lshlrev_b32 v86, 16, v129
  v_and_b32 v87, s82, v129
  v_lshlrev_b32 v88, 16, v130
  v_and_b32 v89, s82, v130
  v_lshlrev_b32 v90, 16, v131
  v_and_b32 v91, s82, v131
  v_lshlrev_b32 v92, 16, v132
  v_and_b32 v93, s82, v132
  v_lshlrev_b32 v94, 16, v133
  v_and_b32 v95, s82, v133
  v_lshlrev_b32 v96, 16, v134
  v_and_b32 v97, s82, v134
  v_lshlrev_b32 v98, 16, v135
  v_and_b32 v99, s82, v135
  s_branch L_warm4
  s_nop 0
L_warm4r:
  s_cmp_lg_u32 s56, 0
  s_cbranch_scc1 L_barc
  v_lshrrev_b32 v24, 1, v1
  s_mov_b64 exec, 0xffff
  s_mov_b32 s6, 0
L_poll2:
  buffer_load_dwordx2 v[16:17], v24, s[44:47], s67 offen offset:0 sc1
  s_waitcnt vmcnt(0)
L_pchk2:
  v_cmp_ne_u64 vcc, s[2:3], v[16:17]
  s_cbranch_vccz L_pdone2
  s_add_u32 s6, s6, 1
  s_cmp_lg_u32 s6, 40
  s_cbranch_scc1 L_poll2
  buffer_wbl2 sc1
  s_waitcnt vmcnt(0)
  s_mov_b64 exec, 1
  v_mov_b32 v16, s4
  v_mov_b32 v17, s5
  v_mov_b32 v18, s69
  buffer_store_dwordx2 v[16:17], v18, s[44:47], s68 offen sc1
  s_mov_b64 exec, 0xffff
L_slow2:
  buffer_load_dwordx2 v[16:17], v24, s[44:47], s67 offen offset:0 sc1
  buffer_load_dwordx2 v[20:21], v24, s[44:47], s68 offen offset:0 sc1
  s_waitcnt vmcnt(0)
  v_cmp_ne_u64 s[60:61], s[2:3], v[16:17]
  v_cmp_ne_u64 vcc, s[4:5], v[20:21]
  s_and_b64 vcc, vcc, s[60:61]
  s_add_u32 s6, s6, 1
  s_cbranch_vccz L_sdone2
  s_cmp_lt_u32 s6, 1048576
  s_cbranch_scc1 L_slow2
L_sdone2:
  buffer_inv sc1
  s_waitcnt vmcnt(0)
L_pdone2:
  s_mov_b64 exec, -1
L_barc:
  s_waitcnt vmcnt(0) lgkmcnt(0)
  s_barrier
  s_add_u32 m0, s24, 0
  s_add_u32 s62, s64, 0
  buffer_load_dwordx4 v1, s[44:47], s62 offen sc1 lds
  s_add_u32 m0, s24, 4096
  s_add_u32 s62, s64, 22528
  buffer_load_dwordx4 v1, s[44:47], s62 offen sc1 lds
  s_add_u32 m0, s24, 8192
  s_add_u32 s62, s64, 1024
  buffer_load_dwordx4 v1, s[44:47], s62 offen sc1 lds
  s_add_u32 m0, s24, 12288
  s_add_u32 s62, s64, 23552
  buffer_load_dwordx4 v1, s[44:47], s62 offen sc1 lds
  s_add_u32 m0, s24, 16384
  s_add_u32 s62, s64, 2048
  buffer_load_dwordx4 v1, s[44:47], s62 offen sc1 lds
  s_add_u32 m0, s24, 20480
  s_add_u32 s62, s64, 24576
  buffer_load_dwordx4 v1, s[44:47], s62 offen sc1 lds
  s_add_u32 m0, s24, 24576
  s_add_u32 s62, s64, 3072
  buffer_load_dwordx4 v1, s[44:47], s62 offen sc1 lds
  s_add_u32 m0, s24, 28672
  s_add_u32 s62, s64, 25600
  buffer_load_dwordx4 v1, s[44:47], s62 offen sc1 lds
  s_add_u32 m0, s24, 32768
  s_add_u32 s62, s64, 4096
  buffer_load_dwordx4 v1, s[44:47], s62 offen sc1 lds
  s_add_u32 m0, s24, 36864
  s_add_u32 s62, s64, 26624
  buffer_load_dwordx4 v1, s[44:47], s62 offen sc1 lds
  v_add_u32 v2, 65536, v125
  s_waitcnt vmcnt(8)
  s_barrier
  ds_read_b128 v[48:51], v3 offset:0
  ds_read_b128 v[52:55], v3 offset:2048
  ds_read_b128 v[56:59], v3 offset:512
  ds_read_b128 v[60:63], v3 offset:2560
  s_waitcnt vmcnt(6)
  s_barrier
  ds_read_b128 v[64:67], v3 offset:8192
  ds_read_b128 v[68:71], v3 offset:10240
  s_waitcnt lgkmcnt(5)
  v_mfma_f32_32x32x16_bf16 v[16:31], a[192:195], v[48:51], 0
  s_waitcnt lgkmcnt(4)
  ds_read_b128 v[72:75], v3 offset:8704
  ds_read_b128 v[76:79], v3 offset:10752
  v_mfma_f32_32x32x16_bf16 v[32:47], a[192:195], v[52:55], 0
  ds_read_b64_tr_b16 v[200:201], v2 offset:0
  ds_read_b64_tr_b16 v[202:203], v2 offset:512
  ds_read_b64_tr_b16 v[204:205], v2 offset:4096
  ds_read_b64_tr_b16 v[206:207], v2 offset:4608
  s_add_u32 m0, s24, 40960
  s_add_u32 s62, s64, 5120
  buffer_load_dwordx4 v1, s[44:47], s62 offen sc1 lds
  s_add_u32 m0, s24, 45056
  s_add_u32 s62, s64, 27648
  buffer_load_dwordx4 v1, s[44:47], s62 offen sc1 lds
  s_waitcnt lgkmcnt(9)
  v_mfma_f32_32x32x16_bf16 v[16:31], a[196:199], v[56:59], v[16:31]
  s_waitcnt vmcnt(4)
  s_barrier
  ds_read_b128 v[48:51], v3 offset:16384
  ds_read_b128 v[52:55], v3 offset:18432
  s_waitcnt lgkmcnt(10)
  v_mfma_f32_32x32x16_bf16 v[32:47], a[196:199], v[60:63], v[32:47]
  s_waitcnt lgkmcnt(9)
  ds_read_b64_tr_b16 v[208:209], v2 offset:8192
  ds_read_b64_tr_b16 v[210:211], v2 offset:8704
  ds_read_b64_tr_b16 v[212:213], v2 offset:12288
  ds_read_b64_tr_b16 v[214:215], v2 offset:12800
  v_mfma_f32_32x32x16_bf16 v[16:31], a[200:203], v[64:67], v[16:31]
  s_waitcnt lgkmcnt(12)
  ds_read_b128 v[56:59], v3 offset:16896
  ds_read_b128 v[60:63], v3 offset:18944
  v_mfma_f32_32x32x16_bf16 v[32:47], a[200:203], v[68:71], v[32:47]
  ds_read_b64_tr_b16 v[216:217], v2 offset:16384
  ds_read_b64_tr_b16 v[218:219], v2 offset:16896
  ds_read_b64_tr_b16 v[220:221], v2 offset:20480
  ds_read_b64_tr_b16 v[222:223], v2 offset:20992
  s_add_u32 m0, s24, 49152
  s_add_u32 s62, s64, 6144
  buffer_load_dwordx4 v1, s[44:47], s62 offen sc1 lds
  s_add_u32 m0, s24, 53248
  s_add_u32 s62, s64, 28672
  buffer_load_dwordx4 v1, s[44:47], s62 offen sc1 lds
  s_waitcnt lgkmcnt(15)
  v_mfma_f32_32x32x16_bf16 v[16:31], a[204:207], v[72:75], v[16:31]
  s_waitcnt lgkmcnt(15)
  ds_read_b128 v[64:67], v3 offset:24576
  ds_read_b128 v[68:71], v3 offset:26624
  v_mfma_f32_32x32x16_bf16 v[32:47], a[204:207], v[76:79], v[32:47]
  s_waitcnt lgkmcnt(13)
  ds_read_b64_tr_b16 v[224:225], v2 offset:24576
  ds_read_b64_tr_b16 v[226:227], v2 offset:25088
  ds_read_b64_tr_b16 v[228:229], v2 offset:28672
  ds_read_b64_tr_b16 v[230:231], v2 offset:29184
  v_mfma_f32_32x32x16_bf16 v[16:31], a[208:211], v[48:51], v[16:31]
  s_waitcnt lgkmcnt(15)
  ds_read_b128 v[72:75], v3 offset:25088
  ds_read_b128 v[76:79], v3 offset:27136
  v_mfma_f32_32x32x16_bf16 v[32:47], a[208:211], v[52:55], v[32:47]
  ds_read_b64_tr_b16 v[232:233], v2 offset:32768
  ds_read_b64_tr_b16 v[234:235], v2 offset:33280
  ds_read_b64_tr_b16 v[236:237], v2 offset:36864
  ds_read_b64_tr_b16 v[238:239], v2 offset:37376
  s_add_u32 m0, s24, 57344
  s_add_u32 s62, s64, 7168
  buffer_load_dwordx4 v1, s[44:47], s62 offen sc1 lds
  s_add_u32 m0, s24, 61440
  s_add_u32 s62, s64, 29696
  buffer_load_dwordx4 v1, s[44:47], s62 offen sc1 lds
  s_waitcnt lgkmcnt(15)
  v_mfma_f32_32x32x16_bf16 v[16:31], a[212:215], v[56:59], v[16:31]
  s_waitcnt vmcnt(4)
  s_barrier
  ds_read_b128 v[48:51], v3 offset:32768
  ds_read_b128 v[52:55], v3 offset:34816
  s_waitcnt lgkmcnt(15)
  v_mfma_f32_32x32x16_bf16 v[32:47], a[212:215], v[60:63], v[32:47]
  s_waitcnt lgkmcnt(13)
  ds_read_b64_tr_b16 v[240:241], v2 offset:40960
  ds_read_b64_tr_b16 v[242:243], v2 offset:41472
  ds_read_b64_tr_b16 v[244:245], v2 offset:45056
  ds_read_b64_tr_b16 v[246:247], v2 offset:45568
  v_mfma_f32_32x32x16_bf16 v[16:31], a[216:219], v[64:67], v[16:31]
  s_waitcnt lgkmcnt(15)
  ds_read_b128 v[56:59], v3 offset:33280
  ds_read_b128 v[60:63], v3 offset:35328
  v_mfma_f32_32x32x16_bf16 v[32:47], a[216:219], v[68:71], v[32:47]
  ds_read_b64_tr_b16 v[248:249], v2 offset:49152
  ds_read_b64_tr_b16 v[250:251], v2 offset:49664
  ds_read_b64_tr_b16 v[252:253], v2 offset:53248
  ds_read_b64_tr_b16 v[254:255], v2 offset:53760
  s_add_u32 m0, s24, 122880
  s_add_u32 s62, s64, 8192
  buffer_load_dwordx4 v1, s[44:47], s62 offen sc1 lds
  s_add_u32 m0, s24, 126976
  s_add_u32 s62, s64, 30720
  buffer_load_dwordx4 v1, s[44:47], s62 offen sc1 lds
  s_waitcnt lgkmcnt(15)
  v_mfma_f32_32x32x16_bf16 v[16:31], a[220:223], v[72:75], v[16:31]
  s_waitcnt lgkmcnt(15)
  ds_read_b128 v[64:67], v3 offset:40960
  ds_read_b128 v[68:71], v3 offset:43008
  v_mfma_f32_32x32x16_bf16 v[32:47], a[220:223], v[76:79], v[32:47]
  s_waitcnt lgkmcnt(13)
  v_mfma_f32_32x32x16_bf16 v[16:31], a[224:227], v[48:51], v[16:31]
  s_waitcnt lgkmcnt(12)
  ds_read_b128 v[72:75], v3 offset:41472
  ds_read_b128 v[76:79], v3 offset:43520
  v_mfma_f32_32x32x16_bf16 v[32:47], a[224:227], v[52:55], v[32:47]
  s_waitcnt lgkmcnt(9)
  s_add_u32 m0, s24, 131072
  s_add_u32 s62, s64, 9216
  buffer_load_dwordx4 v1, s[44:47], s62 offen sc1 lds
  s_add_u32 m0, s24, 135168
  s_add_u32 s62, s64, 31744
  buffer_load_dwordx4 v1, s[44:47], s62 offen sc1 lds
  v_mfma_f32_32x32x16_bf16 v[16:31], a[228:231], v[56:59], v[16:31]
  s_waitcnt vmcnt(4)
  s_barrier
  ds_read_b128 v[48:51], v3 offset:49152
  ds_read_b128 v[52:55], v3 offset:51200
  s_waitcnt lgkmcnt(10)
  v_mfma_f32_32x32x16_bf16 v[32:47], a[228:231], v[60:63], v[32:47]
  s_waitcnt lgkmcnt(5)
  v_mfma_f32_32x32x16_bf16 v[16:31], a[232:235], v[64:67], v[16:31]
  s_waitcnt lgkmcnt(4)
  ds_read_b128 v[56:59], v3 offset:49664
  ds_read_b128 v[60:63], v3 offset:51712
  v_mfma_f32_32x32x16_bf16 v[32:47], a[232:235], v[68:71], v[32:47]
  s_waitcnt lgkmcnt(5)
  s_add_u32 m0, s24, 139264
  s_add_u32 s62, s64, 10240
  buffer_load_dwordx4 v1, s[44:47], s62 offen sc1 lds
  s_add_u32 m0, s24, 143360
  s_add_u32 s62, s64, 32768
  buffer_load_dwordx4 v1, s[44:47], s62 offen sc1 lds
  v_mfma_f32_32x32x16_bf16 v[16:31], a[236:239], v[72:75], v[16:31]
  s_waitcnt lgkmcnt(4)
  ds_read_b128 v[64:67], v3 offset:57344
  ds_read_b128 v[68:71], v3 offset:59392
  v_mfma_f32_32x32x16_bf16 v[32:47], a[236:239], v[76:79], v[32:47]
  s_waitcnt lgkmcnt(5)
  v_mfma_f32_32x32x16_bf16 v[16:31], a[240:243], v[48:51], v[16:31]
  s_waitcnt lgkmcnt(4)
  ds_read_b128 v[72:75], v3 offset:57856
  ds_read_b128 v[76:79], v3 offset:59904
  v_mfma_f32_32x32x16_bf16 v[32:47], a[240:243], v[52:55], v[32:47]
  s_waitcnt lgkmcnt(5)
  s_add_u32 m0, s24, 147456
  s_add_u32 s62, s65, 11264
  buffer_load_dwordx4 v1, s[44:47], s62 offen sc1 lds
  s_add_u32 m0, s24, 151552
  s_add_u32 s62, s65, 33792
  buffer_load_dwordx4 v1, s[44:47], s62 offen sc1 lds
  v_mfma_f32_32x32x16_bf16 v[16:31], a[244:247], v[56:59], v[16:31]
  s_waitcnt vmcnt(4)
  s_barrier
  ds_read_b128 v[48:51], v4 offset:57344
  ds_read_b128 v[52:55], v4 offset:59392
  s_waitcnt lgkmcnt(6)
  v_mfma_f32_32x32x16_bf16 v[32:47], a[244:247], v[60:63], v[32:47]
  s_waitcnt lgkmcnt(5)
  v_mfma_f32_32x32x16_bf16 v[16:31], a[248:251], v[64:67], v[16:31]
  s_waitcnt lgkmcnt(4)
  ds_read_b128 v[56:59], v4 offset:57856
  ds_read_b128 v[60:63], v4 offset:59904
  v_mfma_f32_32x32x16_bf16 v[32:47], a[248:251], v[68:71], v[32:47]
  s_waitcnt lgkmcnt(5)
  s_add_u32 m0, s24, 155648
  s_add_u32 s62, s65, 12288
  buffer_load_dwordx4 v1, s[44:47], s62 offen sc1 lds
  s_add_u32 m0, s24, 159744
  s_add_u32 s62, s65, 34816
  buffer_load_dwordx4 v1, s[44:47], s62 offen sc1 lds
  v_mfma_f32_32x32x16_bf16 v[16:31], a[252:255], v[72:75], v[16:31]
  s_waitcnt lgkmcnt(4)
  ds_read_b128 v[64:67], v5 offset:0
  ds_read_b128 v[68:71], v5 offset:2048
  v_mfma_f32_32x32x16_bf16 v[32:47], a[252:255], v[76:79], v[32:47]
  s_waitcnt lgkmcnt(5)
  v_mfma_f32_32x32x16_bf16 v[16:31], v[144:147], v[48:51], v[16:31]
  s_waitcnt lgkmcnt(4)
  ds_read_b128 v[72:75], v5 offset:512
  ds_read_b128 v[76:79], v5 offset:2560
  v_mfma_f32_32x32x16_bf16 v[32:47], v[144:147], v[52:55], v[32:47]
  s_waitcnt lgkmcnt(5)
  s_add_u32 m0, s24, 65536
  s_add_u32 s62, s65, 13312
  buffer_load_dwordx4 v1, s[44:47], s62 offen sc1 lds
  s_add_u32 m0, s24, 69632
  s_add_u32 s62, s65, 35840
  buffer_load_dwordx4 v1, s[44:47], s62 offen sc1 lds
  v_mfma_f32_32x32x16_bf16 v[16:31], v[148:151], v[56:59], v[16:31]
  s_waitcnt vmcnt(4)
  s_barrier
  ds_read_b128 v[48:51], v5 offset:8192
  ds_read_b128 v[52:55], v5 offset:10240
  s_waitcnt lgkmcnt(6)
  v_mfma_f32_32x32x16_bf16 v[32:47], v[148:151], v[60:63], v[32:47]
  s_waitcnt lgkmcnt(5)
  v_mfma_f32_32x32x16_bf16 v[16:31], v[152:155], v[64:67], v[16:31]
  s_waitcnt lgkmcnt(4)
  ds_read_b128 v[56:59], v5 offset:8704
  ds_read_b128 v[60:63], v5 offset:10752
  v_mfma_f32_32x32x16_bf16 v[32:47], v[152:155], v[68:71], v[32:47]
  s_waitcnt lgkmcnt(5)
  s_add_u32 m0, s24, 73728
  s_add_u32 s62, s65, 14336
  buffer_load_dwordx4 v1, s[44:47], s62 offen sc1 lds
  s_add_u32 m0, s24, 77824
  s_add_u32 s62, s65, 36864
  buffer_load_dwordx4 v1, s[44:47], s62 offen sc1 lds
  v_mfma_f32_32x32x16_bf16 v[16:31], v[156:159], v[72:75], v[16:31]
  s_waitcnt lgkmcnt(4)
  ds_read_b128 v[64:67], v5 offset:16384
  ds_read_b128 v[68:71], v5 offset:18432
  v_mfma_f32_32x32x16_bf16 v[32:47], v[156:159], v[76:79], v[32:47]
  s_waitcnt lgkmcnt(5)
  v_mfma_f32_32x32x16_bf16 v[16:31], v[160:163], v[48:51], v[16:31]
  s_waitcnt lgkmcnt(4)
  ds_read_b128 v[72:75], v5 offset:16896
  ds_read_b128 v[76:79], v5 offset:18944
  v_mfma_f32_32x32x16_bf16 v[32:47], v[160:163], v[52:55], v[32:47]
  s_waitcnt lgkmcnt(5)
  s_add_u32 m0, s24, 81920
  s_add_u32 s62, s65, 15360
  buffer_load_dwordx4 v1, s[44:47], s62 offen sc1 lds
  s_add_u32 m0, s24, 86016
  s_add_u32 s62, s65, 37888
  buffer_load_dwordx4 v1, s[44:47], s62 offen sc1 lds
  v_mfma_f32_32x32x16_bf16 v[16:31], v[164:167], v[56:59], v[16:31]
  s_waitcnt vmcnt(4)
  s_barrier
  ds_read_b128 v[48:51], v5 offset:24576
  ds_read_b128 v[52:55], v5 offset:26624
  s_waitcnt lgkmcnt(6)
  v_mfma_f32_32x32x16_bf16 v[32:47], v[164:167], v[60:63], v[32:47]
  s_waitcnt lgkmcnt(5)
  v_mfma_f32_32x32x16_bf16 v[16:31], v[168:171], v[64:67], v[16:31]
  s_waitcnt lgkmcnt(4)
  ds_read_b128 v[56:59], v5 offset:25088
  ds_read_b128 v[60:63], v5 offset:27136
  v_mfma_f32_32x32x16_bf16 v[32:47], v[168:171], v[68:71], v[32:47]
  s_waitcnt lgkmcnt(5)
  s_add_u32 m0, s24, 90112
  s_add_u32 s62, s65, 16384
  buffer_load_dwordx4 v1, s[44:47], s62 offen sc1 lds
  s_add_u32 m0, s24, 94208
  s_add_u32 s62, s65, 38912
  buffer_load_dwordx4 v1, s[44:47], s62 offen sc1 lds
  v_mfma_f32_32x32x16_bf16 v[16:31], v[172:175], v[72:75], v[16:31]
  s_waitcnt lgkmcnt(4)
  ds_read_b128 v[64:67], v4 offset:0
  ds_read_b128 v[68:71], v4 offset:2048
  v_mfma_f32_32x32x16_bf16 v[32:47], v[172:175], v[76:79], v[32:47]
  s_waitcnt lgkmcnt(5)
  v_mfma_f32_32x32x16_bf16 v[16:31], v[176:179], v[48:51], v[16:31]
  s_waitcnt lgkmcnt(4)
  ds_read_b128 v[72:75], v4 offset:512
  ds_read_b128 v[76:79], v4 offset:2560
  v_mfma_f32_32x32x16_bf16 v[32:47], v[176:179], v[52:55], v[32:47]
  s_waitcnt lgkmcnt(5)
  s_add_u32 m0, s24, 98304
  s_add_u32 s62, s65, 17408
  buffer_load_dwordx4 v1, s[44:47], s62 offen sc1 lds
  s_add_u32 m0, s24, 102400
  s_add_u32 s62, s65, 39936
  buffer_load_dwordx4 v1, s[44:47], s62 offen sc1 lds
  v_mfma_f32_32x32x16_bf16 v[16:31], v[180:183], v[56:59], v[16:31]
  s_waitcnt vmcnt(4)
  s_barrier
  ds_read_b128 v[48:51], v4 offset:8192
  ds_read_b128 v[52:55], v4 offset:10240
  s_waitcnt lgkmcnt(6)
  v_mfma_f32_32x32x16_bf16 v[32:47], v[180:183], v[60:63], v[32:47]
  s_waitcnt lgkmcnt(5)
  v_mfma_f32_32x32x16_bf16 v[16:31], v[184:187], v[64:67], v[16:31]
  s_waitcnt lgkmcnt(4)
  ds_read_b128 v[56:59], v4 offset:8704
  ds_read_b128 v[60:63], v4 offset:10752
  v_mfma_f32_32x32x16_bf16 v[32:47], v[184:187], v[68:71], v[32:47]
  s_waitcnt lgkmcnt(5)
  s_add_u32 m0, s24, 106496
  s_add_u32 s62, s65, 18432
  buffer_load_dwordx4 v1, s[44:47], s62 offen sc1 lds
  s_add_u32 m0, s24, 110592
  s_add_u32 s62, s65, 40960
  buffer_load_dwordx4 v1, s[44:47], s62 offen sc1 lds
  v_mfma_f32_32x32x16_bf16 v[16:31], v[188:191], v[72:75], v[16:31]
  s_waitcnt lgkmcnt(4)
  ds_read_b128 v[64:67], v4 offset:16384
  ds_read_b128 v[68:71], v4 offset:18432
  v_mfma_f32_32x32x16_bf16 v[32:47], v[188:191], v[76:79], v[32:47]
  s_waitcnt lgkmcnt(5)
  v_mfma_f32_32x32x16_bf16 v[16:31], v[192:195], v[48:51], v[16:31]
  s_waitcnt lgkmcnt(4)
  ds_read_b128 v[72:75], v4 offset:16896
  ds_read_b128 v[76:79], v4 offset:18944
  v_mfma_f32_32x32x16_bf16 v[32:47], v[192:195], v[52:55], v[32:47]
  s_waitcnt lgkmcnt(5)
  s_add_u32 m0, s24, 114688
  s_add_u32 s62, s65, 19456
  buffer_load_dwordx4 v1, s[44:47], s62 offen sc1 lds
  s_add_u32 m0, s24, 118784
  s_add_u32 s62, s65, 41984
  buffer_load_dwordx4 v1, s[44:47], s62 offen sc1 lds
  v_mfma_f32_32x32x16_bf16 v[16:31], v[196:199], v[56:59], v[16:31]
  s_waitcnt vmcnt(4)
  s_barrier
  ds_read_b128 v[48:51], v4 offset:24576
  ds_read_b128 v[52:55], v4 offset:26624
  s_waitcnt lgkmcnt(6)
  v_mfma_f32_32x32x16_bf16 v[32:47], v[196:199], v[60:63], v[32:47]
  s_waitcnt lgkmcnt(5)
  v_mfma_f32_32x32x16_bf16 v[16:31], v[200:203], v[64:67], v[16:31]
  s_waitcnt lgkmcnt(4)
  ds_read_b128 v[56:59], v4 offset:25088
  ds_read_b128 v[60:63], v4 offset:27136
  v_mfma_f32_32x32x16_bf16 v[32:47], v[200:203], v[68:71], v[32:47]
  s_waitcnt lgkmcnt(5)
  s_add_u32 m0, s24, 0
  s_add_u32 s62, s65, 20480
  buffer_load_dwordx4 v1, s[44:47], s62 offen sc1 lds
  s_add_u32 m0, s24, 4096
  s_add_u32 s62, s65, 43008
  buffer_load_dwordx4 v1, s[44:47], s62 offen sc1 lds
  v_mfma_f32_32x32x16_bf16 v[16:31], v[204:207], v[72:75], v[16:31]
  s_waitcnt lgkmcnt(4)
  ds_read_b128 v[64:67], v4 offset:32768
  ds_read_b128 v[68:71], v4 offset:34816
  v_mfma_f32_32x32x16_bf16 v[32:47], v[204:207], v[76:79], v[32:47]
  s_waitcnt lgkmcnt(5)
  v_mfma_f32_32x32x16_bf16 v[16:31], v[208:211], v[48:51], v[16:31]
  s_waitcnt lgkmcnt(4)
  ds_read_b128 v[72:75], v4 offset:33280
  ds_read_b128 v[76:79], v4 offset:35328
  v_mfma_f32_32x32x16_bf16 v[32:47], v[208:211], v[52:55], v[32:47]
  s_waitcnt lgkmcnt(5)
  s_add_u32 m0, s24, 8192
  s_add_u32 s62, s65, 21504
  buffer_load_dwordx4 v1, s[44:47], s62 offen sc1 lds
  s_add_u32 m0, s24, 12288
  s_add_u32 s62, s65, 44032
  buffer_load_dwordx4 v1, s[44:47], s62 offen sc1 lds
  v_mfma_f32_32x32x16_bf16 v[16:31], v[212:215], v[56:59], v[16:31]
  s_waitcnt vmcnt(4)
  s_barrier
  ds_read_b128 v[48:51], v4 offset:40960
  ds_read_b128 v[52:55], v4 offset:43008
  s_waitcnt lgkmcnt(6)
  v_mfma_f32_32x32x16_bf16 v[32:47], v[212:215], v[60:63], v[32:47]
  s_waitcnt lgkmcnt(5)
  v_mfma_f32_32x32x16_bf16 v[16:31], v[216:219], v[64:67], v[16:31]
  s_waitcnt lgkmcnt(4)
  ds_read_b128 v[56:59], v4 offset:41472
  ds_read_b128 v[60:63], v4 offset:43520
  v_mfma_f32_32x32x16_bf16 v[32:47], v[216:219], v[68:71], v[32:47]
  s_waitcnt lgkmcnt(5)
  v_mfma_f32_32x32x16_bf16 v[16:31], v[220:223], v[72:75], v[16:31]
  s_waitcnt lgkmcnt(4)
  ds_read_b128 v[64:67], v4 offset:49152
  ds_read_b128 v[68:71], v4 offset:51200
  v_mfma_f32_32x32x16_bf16 v[32:47], v[220:223], v[76:79], v[32:47]
  s_waitcnt lgkmcnt(5)
  v_mfma_f32_32x32x16_bf16 v[16:31], v[224:227], v[48:51], v[16:31]
  s_waitcnt lgkmcnt(4)
  ds_read_b128 v[72:75], v4 offset:49664
  ds_read_b128 v[76:79], v4 offset:51712
  v_mfma_f32_32x32x16_bf16 v[32:47], v[224:227], v[52:55], v[32:47]
  s_waitcnt lgkmcnt(5)
  v_mfma_f32_32x32x16_bf16 v[16:31], v[228:231], v[56:59], v[16:31]
  s_waitcnt vmcnt(2)
  s_barrier
  ds_read_b128 v[48:51], v3 offset:0
  ds_read_b128 v[52:55], v3 offset:2048
  s_waitcnt lgkmcnt(6)
  v_mfma_f32_32x32x16_bf16 v[32:47], v[228:231], v[60:63], v[32:47]
  s_waitcnt lgkmcnt(5)
  v_mfma_f32_32x32x16_bf16 v[16:31], v[232:235], v[64:67], v[16:31]
  s_waitcnt lgkmcnt(4)
  ds_read_b128 v[56:59], v3 offset:512
  ds_read_b128 v[60:63], v3 offset:2560
  v_mfma_f32_32x32x16_bf16 v[32:47], v[232:235], v[68:71], v[32:47]
  s_waitcnt lgkmcnt(5)
  v_mfma_f32_32x32x16_bf16 v[16:31], v[236:239], v[72:75], v[16:31]
  s_waitcnt vmcnt(0)
  s_barrier
  ds_read_b128 v[64:67], v3 offset:8192
  ds_read_b128 v[68:71], v3 offset:10240
  s_waitcnt lgkmcnt(6)
  v_mfma_f32_32x32x16_bf16 v[32:47], v[236:239], v[76:79], v[32:47]
  s_waitcnt lgkmcnt(5)
  v_mfma_f32_32x32x16_bf16 v[16:31], v[240:243], v[48:51], v[16:31]
  s_waitcnt lgkmcnt(4)
  ds_read_b128 v[72:75], v3 offset:8704
  ds_read_b128 v[76:79], v3 offset:10752
  v_mfma_f32_32x32x16_bf16 v[32:47], v[240:243], v[52:55], v[32:47]
  s_waitcnt lgkmcnt(5)
  v_mfma_f32_32x32x16_bf16 v[16:31], v[244:247], v[56:59], v[16:31]
  s_waitcnt lgkmcnt(4)
  v_mfma_f32_32x32x16_bf16 v[32:47], v[244:247], v[60:63], v[32:47]
  s_waitcnt lgkmcnt(3)
  v_mfma_f32_32x32x16_bf16 v[16:31], v[248:251], v[64:67], v[16:31]
  s_waitcnt lgkmcnt(2)
  v_mfma_f32_32x32x16_bf16 v[32:47], v[248:251], v[68:71], v[32:47]
  s_waitcnt lgkmcnt(1)
  v_mfma_f32_32x32x16_bf16 v[16:31], v[252:255], v[72:75], v[16:31]
  s_waitcnt lgkmcnt(0)
  v_mfma_f32_32x32x16_bf16 v[32:47], v[252:255], v[76:79], v[32:47]
  s_cmp_ge_u32 s56, 2
  s_cbranch_scc1 L_p3hi
  s_nop 7
  s_nop 2
  ds_write_b128 v80, v[32:35] offset:24576
  ds_write_b128 v80, v[36:39] offset:25600
  ds_write_b128 v80, v[40:43] offset:26624
  ds_write_b128 v80, v[44:47] offset:27648
  v_pk_add_f32 v[16:17], v[16:17], v[84:85]
  v_pk_add_f32 v[18:19], v[18:19], v[86:87]
  v_pk_add_f32 v[20:21], v[20:21], v[88:89]
  v_pk_add_f32 v[22:23], v[22:23], v[90:91]
  v_pk_add_f32 v[24:25], v[24:25], v[92:93]
  v_pk_add_f32 v[26:27], v[26:27], v[94:95]
  v_pk_add_f32 v[28:29], v[28:29], v[96:97]
  v_pk_add_f32 v[30:31], v[30:31], v[98:99]
  s_waitcnt lgkmcnt(0)
  s_barrier
  ds_read_b128 v[32:35], v81 offset:24576
  ds_read_b128 v[36:39], v81 offset:25600
  ds_read_b128 v[40:43], v81 offset:26624
  ds_read_b128 v[44:47], v81 offset:27648
  s_waitcnt lgkmcnt(3)
  v_pk_add_f32 v[16:17], v[16:17], v[32:33]
  v_pk_add_f32 v[18:19], v[18:19], v[34:35]
  v_cvt_pk_bf16_f32 v100, v16, v17
  v_cvt_pk_bf16_f32 v101, v18, v19
  s_waitcnt lgkmcnt(2)
  v_pk_add_f32 v[20:21], v[20:21], v[36:37]
  v_pk_add_f32 v[22:23], v[22:23], v[38:39]
  v_cvt_pk_bf16_f32 v102, v20, v21
  v_cvt_pk_bf16_f32 v103, v22, v23
  s_nop 1
  v_permlane32_swap_b32 v100, v102
  v_permlane32_swap_b32 v101, v103
  buffer_store_dwordx4 v[100:103], v82, s[40:43], s66 offen offset:0
  s_waitcnt lgkmcnt(1)
  v_pk_add_f32 v[24:25], v[24:25], v[40:41]
  v_pk_add_f32 v[26:27], v[26:27], v[42:43]
  v_cvt_pk_bf16_f32 v104, v24, v25
  v_cvt_pk_bf16_f32 v105, v26, v27
  s_waitcnt lgkmcnt(0)
  v_pk_add_f32 v[28:29], v[28:29], v[44:45]
  v_pk_add_f32 v[30:31], v[30:31], v[46:47]
  v_cvt_pk_bf16_f32 v106, v28, v29
  v_cvt_pk_bf16_f32 v107, v30, v31
  s_nop 1
  v_permlane32_swap_b32 v104, v106
  v_permlane32_swap_b32 v105, v107
  buffer_store_dwordx4 v[104:107], v82, s[40:43], s66 offen offset:32
  s_branch L_p3done
.p2align 6
L_warm4:
  s_branch L_warm4r
L_p3hi:
  s_nop 7
  s_nop 2
  ds_write_b128 v80, v[16:19] offset:24576
  ds_write_b128 v80, v[20:23] offset:25600
  ds_write_b128 v80, v[24:27] offset:26624
  ds_write_b128 v80, v[28:31] offset:27648
  v_pk_add_f32 v[32:33], v[32:33], v[84:85]
  v_pk_add_f32 v[34:35], v[34:35], v[86:87]
  v_pk_add_f32 v[36:37], v[36:37], v[88:89]
  v_pk_add_f32 v[38:39], v[38:39], v[90:91]
  v_pk_add_f32 v[40:41], v[40:41], v[92:93]
  v_pk_add_f32 v[42:43], v[42:43], v[94:95]
  v_pk_add_f32 v[44:45], v[44:45], v[96:97]
  v_pk_add_f32 v[46:47], v[46:47], v[98:99]
  s_waitcnt lgkmcnt(0)
  s_barrier
  ds_read_b128 v[16:19], v81 offset:24576
  ds_read_b128 v[20:23], v81 offset:25600
  ds_read_b128 v[24:27], v81 offset:26624
  ds_read_b128 v[28:31], v81 offset:27648
  s_waitcnt lgkmcnt(3)
  v_pk_add_f32 v[32:33], v[32:33], v[16:17]
  v_pk_add_f32 v[34:35], v[34:35], v[18:19]
  v_cvt_pk_bf16_f32 v100, v32, v33
  v_cvt_pk_bf16_f32 v101, v34, v35
  s_waitcnt lgkmcnt(2)
  v_pk_add_f32 v[36:37], v[36:37], v[20:21]
  v_pk_add_f32 v[38:39], v[38:39], v[22:23]
  v_cvt_pk_bf16_f32 v102, v36, v37
  v_cvt_pk_bf16_f32 v103, v38, v39
  s_nop 1
  v_permlane32_swap_b32 v100, v102
  v_permlane32_swap_b32 v101, v103
  buffer_store_dwordx4 v[100:103], v82, s[40:43], s66 offen offset:0
  s_waitcnt lgkmcnt(1)
  v_pk_add_f32 v[40:41], v[40:41], v[24:25]
  v_pk_add_f32 v[42:43], v[42:43], v[26:27]
  v_cvt_pk_bf16_f32 v104, v40, v41
  v_cvt_pk_bf16_f32 v105, v42, v43
  s_waitcnt lgkmcnt(0)
  v_pk_add_f32 v[44:45], v[44:45], v[28:29]
  v_pk_add_f32 v[46:47], v[46:47], v[30:31]
  v_cvt_pk_bf16_f32 v106, v44, v45
  v_cvt_pk_bf16_f32 v107, v46, v47
  s_nop 1
  v_permlane32_swap_b32 v104, v106
  v_permlane32_swap_b32 v105, v107
  buffer_store_dwordx4 v[104:107], v82, s[40:43], s66 offen offset:32
L_p3done:
  s_waitcnt vmcnt(0)
  s_waitcnt vmcnt(0)
  s_endpgm
L_rt0:
  s_mov_b32 s6, 0
L_rtl0:
  ds_read_b128 v[108:111], v12 offset:0
  s_waitcnt lgkmcnt(0)
  v_cmp_ne_u32 vcc, s21, v111
  s_cbranch_vccz L_bk0
  s_add_u32 s6, s6, 1
  s_cmp_lt_u32 s6, 1048576
  s_cbranch_scc1 L_rtl0
  s_branch L_bk0
L_rt1:
  s_mov_b32 s6, 0
L_rtl1:
  ds_read_b128 v[112:115], v12 offset:256
  s_waitcnt lgkmcnt(0)
  v_cmp_ne_u32 vcc, s21, v115
  s_cbranch_vccz L_bk1
  s_add_u32 s6, s6, 1
  s_cmp_lt_u32 s6, 1048576
  s_cbranch_scc1 L_rtl1
  s_branch L_bk1
L_rt2:
  s_mov_b32 s6, 0
L_rtl2:
  ds_read_b128 v[108:111], v12 offset:512
  s_waitcnt lgkmcnt(0)
  v_cmp_ne_u32 vcc, s21, v111
  s_cbranch_vccz L_bk2
  s_add_u32 s6, s6, 1
  s_cmp_lt_u32 s6, 1048576
  s_cbranch_scc1 L_rtl2
  s_branch L_bk2
L_rt3:
  s_mov_b32 s6, 0
L_rtl3:
  ds_read_b128 v[112:115], v12 offset:768
  s_waitcnt lgkmcnt(0)
  v_cmp_ne_u32 vcc, s21, v115
  s_cbranch_vccz L_bk3
  s_add_u32 s6, s6, 1
  s_cmp_lt_u32 s6, 1048576
  s_cbranch_scc1 L_rtl3
  s_branch L_bk3
L_rt4:
  s_mov_b32 s6, 0
L_rtl4:
  ds_read_b128 v[108:111], v12 offset:1024
  s_waitcnt lgkmcnt(0)
  v_cmp_ne_u32 vcc, s21, v111
  s_cbranch_vccz L_bk4
  s_add_u32 s6, s6, 1
  s_cmp_lt_u32 s6, 1048576
  s_cbranch_scc1 L_rtl4
  s_branch L_bk4
L_rt5:
  s_mov_b32 s6, 0
L_rtl5:
  ds_read_b128 v[112:115], v12 offset:1280
  s_waitcnt lgkmcnt(0)
  v_cmp_ne_u32 vcc, s21, v115
  s_cbranch_vccz L_bk5
  s_add_u32 s6, s6, 1
  s_cmp_lt_u32 s6, 1048576
  s_cbranch_scc1 L_rtl5
  s_branch L_bk5
L_rt6:
  s_mov_b32 s6, 0
L_rtl6:
  ds_read_b128 v[108:111], v12 offset:1536
  s_waitcnt lgkmcnt(0)
  v_cmp_ne_u32 vcc, s21, v111
  s_cbranch_vccz L_bk6
  s_add_u32 s6, s6, 1
  s_cmp_lt_u32 s6, 1048576
  s_cbranch_scc1 L_rtl6
  s_branch L_bk6
L_rt7:
  s_mov_b32 s6, 0
L_rtl7:
  ds_read_b128 v[112:115], v12 offset:1792
  s_waitcnt lgkmcnt(0)
  v_cmp_ne_u32 vcc, s21, v115
  s_cbranch_vccz L_bk7
  s_add_u32 s6, s6, 1
  s_cmp_lt_u32 s6, 1048576
  s_cbranch_scc1 L_rtl7
  s_branch L_bk7
L_end:
  s_endpgm
.section .rodata,"a"
.p2align 6
.amdhsa_kernel sequential_preLN__ssm_conv_h3__glu_gated_glu__prompt_kernel
  .amdhsa_next_free_vgpr 512
  .amdhsa_next_free_sgpr 102
  .amdhsa_accum_offset 256
  .amdhsa_group_segment_fixed_size 0
  .amdhsa_kernarg_size 104
  .amdhsa_user_sgpr_count 2
  .amdhsa_user_sgpr_kernarg_segment_ptr 1
  .amdhsa_system_sgpr_workgroup_id_x 1
  .amdhsa_float_denorm_mode_32 3
.end_amdhsa_kernel
```
